```python
import torch

def _softmax(x, axis=-1):
    return torch.softmax(x, dim=axis)
def _gelu(x):
    return torch.nn.functional.gelu(x, approximate="tanh")
def _silu(x):
    return torch.nn.functional.silu(x)
def _sigmoid(x):
    return torch.sigmoid(x)
def _layernorm(x, axis=-1, eps=1e-5):
    m = x.mean(dim=axis, keepdim=True)
    v = x.var(dim=axis, keepdim=True, unbiased=False)
    return (x - m) / torch.sqrt(v + eps)
def _scatter_add(tgt, idx, src, axis=0):
    return tgt.clone().index_add_(axis, idx, src)
def _segment_sum(src, seg, n):
    out = torch.zeros((n,) + src.shape[1:], dtype=src.dtype)
    return out.index_add_(0, seg, src)
def _pad(x, pw):
    flat = tuple(v for pair in reversed(pw) for v in pair)
    return torch.nn.functional.pad(x, flat)

kernel_name = 'gather_scatter__edge_featured_mpnn_gatedgcn__graph'

def setup_inputs():

    _w = (lambda a: (lambda t: t.to(torch.bfloat16) if t.is_floating_point() else t)(torch.as_tensor(a)))
    N, deg, D, De = 50000, 16, 64, max(0, 1)
    E = N * deg
    return {
        "x": _w((lambda *s: torch.randn(*s, dtype=torch.bfloat16) * 0.4)(N, D)),
        "e_attr": _w((lambda *s: torch.randn(*s, dtype=torch.bfloat16) * 0.8)(E, De)),
        "src": _w((lambda lo, hi, *s: torch.randint(lo, hi, s))(0, N, E).to(torch.int64)),
        "dst": _w((lambda lo, hi, *s: torch.randint(lo, hi, s))(0, N, E).to(torch.int64)),
        "w_a": _w((lambda *s: torch.randn(*s, dtype=torch.bfloat16) * 0.8)(D, D)),
        "w_b": _w((lambda *s: torch.randn(*s, dtype=torch.bfloat16) * 0.4)(D, D)),
        "w_c": _w((lambda *s: torch.randn(*s, dtype=torch.bfloat16) * 0.8)(De, D)),
        "w_u": _w((lambda *s: torch.randn(*s, dtype=torch.bfloat16) * 0.05)(D, D)),
        "w_v": _w((lambda *s: torch.randn(*s, dtype=torch.bfloat16) * 0.05)(D, D)),
    }

def reference(x, e_attr, src, dst, w_a, w_b, w_c, w_u, w_v):
    N, D = x.shape
    hv = x @ w_v
    g = x[dst] @ w_a + x[src] @ w_b + e_attr @ w_c
    eta = _sigmoid(g)
    denom = _segment_sum(eta, dst, N) + 1e-6
    eta_n = eta / denom[dst]
    agg = _segment_sum(eta_n * hv[src], dst, N)
    z = x @ w_u + agg
    relu_z = torch.where(z > 0, z, 0 * z)
    return x + relu_z
```

```asm
; @launch kernel=gcn_bin_kernel grid=(255,1,1) block=(800,1,1) lds=27648
; @launch kernel=gather_scatter__edge_featured_mpnn_gatedgcn__graph_kernel grid=(256,1,1) block=(512,1,1) lds=163840
.amdgcn_target "amdgcn-amd-amdhsa--gfx950"
.text
.globl gcn_bin_kernel
.p2align 8
.type gcn_bin_kernel,@function
gcn_bin_kernel:
    s_cmp_ge_u32 s2, 250
    s_cbranch_scc1 K1_W
    s_load_dwordx2 s[4:5], s[0:1], 8
    s_load_dwordx4 s[8:11], s[0:1], 16
    s_load_dwordx2 s[6:7], s[0:1], 88
    v_lshlrev_b32 v1, 4, v0
    s_mul_i32 s3, s2, 12800
    v_add_u32 v2, s3, v1
    v_lshrrev_b32 v3, 1, v2
    v_mov_b32 v4, 0
    v_mov_b32 v5, 0
    v_mov_b32 v6, 0
    v_mov_b32 v7, 0
    v_lshrrev_b32 v18, 6, v0
    v_mov_b32 v19, 1
    s_waitcnt lgkmcnt(0)
    global_load_dwordx4 v[8:11], v2, s[10:11]
    global_load_dwordx4 v[12:15], v2, s[8:9]
    global_load_dwordx2 v[16:17], v3, s[4:5]
    ds_write_b128 v1, v[4:7]
    ds_write_b128 v1, v[4:7] offset:12800
    v_readfirstlane_b32 s12, v18
    s_mov_b32 s13, 4294967247
    s_mov_b32 s14, 0xffff0000
    s_mul_i32 s15, s2, 19840
    s_waitcnt lgkmcnt(0)
    s_barrier
    s_lshl_b32 s16, s2, 10
    s_add_u32 s16, s16, 5242880
    v_add_u32 v44, s16, v1
    s_movk_i32 s17, 21846
    v_mov_b32 v45, 43692
    v_add_u32 v2, s15, v1
    v_add_u32 v3, 12800, v2
    s_cmp_lg_u32 s12, 0
    s_cselect_b32 s16, 0x40000, 0
    v_add_u32 v54, s16, v1
    s_waitcnt vmcnt(2)
    v_mul_u32_u24 v20, 85599, v8
    v_lshlrev_b32_sdwa v24, 2, v20 dst_sel:DWORD dst_unused:UNUSED_PAD src0_sel:DWORD src1_sel:BYTE_3
    ds_add_rtn_u32 v28, v24, v19
    v_mul_u32_u24 v21, 85599, v9
    v_lshlrev_b32_sdwa v25, 2, v21 dst_sel:DWORD dst_unused:UNUSED_PAD src0_sel:DWORD src1_sel:BYTE_3
    ds_add_rtn_u32 v29, v25, v19
    v_mul_u32_u24 v22, 85599, v10
    v_lshlrev_b32_sdwa v26, 2, v22 dst_sel:DWORD dst_unused:UNUSED_PAD src0_sel:DWORD src1_sel:BYTE_3
    ds_add_rtn_u32 v30, v26, v19
    v_mul_u32_u24 v23, 85599, v11
    v_lshlrev_b32_sdwa v27, 2, v23 dst_sel:DWORD dst_unused:UNUSED_PAD src0_sel:DWORD src1_sel:BYTE_3
    ds_add_rtn_u32 v31, v27, v19
    v_mad_i32_i24 v8, v24, s13, v8
    v_add_u32 v8, 1, v8
    v_mad_i32_i24 v9, v25, s13, v9
    v_add_u32 v9, 1, v9
    v_mad_i32_i24 v10, v26, s13, v10
    v_add_u32 v10, 1, v10
    v_mad_i32_i24 v11, v27, s13, v11
    v_add_u32 v11, 1, v11
    s_waitcnt vmcnt(0)
    v_lshl_or_b32 v12, v16, 16, v12
    v_and_or_b32 v13, v16, s14, v13
    v_lshl_or_b32 v14, v17, 16, v14
    v_and_or_b32 v15, v17, s14, v15
    s_waitcnt lgkmcnt(0)
    s_barrier
    ds_read_b128 v[32:35], v54
    v_mul_u32_u24 v20, 21846, v28
    v_lshrrev_b32 v20, 16, v20
    v_add_lshl_u32 v46, v28, v20, 2
    v_mad_u32_u24 v50, v20, 13, v28
    v_mul_u32_u24 v21, 21846, v29
    v_lshrrev_b32 v21, 16, v21
    v_add_lshl_u32 v47, v29, v21, 2
    v_mad_u32_u24 v51, v21, 13, v29
    v_mul_u32_u24 v22, 21846, v30
    v_lshrrev_b32 v22, 16, v22
    v_add_lshl_u32 v48, v30, v22, 2
    v_mad_u32_u24 v52, v22, 13, v30
    v_mul_u32_u24 v23, 21846, v31
    v_lshrrev_b32 v23, 16, v23
    v_add_lshl_u32 v49, v31, v23, 2
    v_mad_u32_u24 v53, v23, 13, v31
    s_cbranch_scc1 K1_NOSCAN
    s_waitcnt lgkmcnt(0)
    v_mad_u32_u24 v32, v32, s17, v45
    v_lshrrev_b32 v32, 16, v32
    v_mad_u32_u24 v33, v33, s17, v45
    v_lshrrev_b32 v33, 16, v33
    v_mad_u32_u24 v34, v34, s17, v45
    v_lshrrev_b32 v34, 16, v34
    v_mad_u32_u24 v35, v35, s17, v45
    v_lshrrev_b32 v35, 16, v35
    v_add_u32 v38, v32, v33
    v_add_u32 v39, v38, v34
    v_add_u32 v40, v39, v35
    v_mov_b32 v41, v40
    s_nop 1
    v_add_u32_dpp v41, v41, v41 row_shr:1 row_mask:0xf bank_mask:0xf bound_ctrl:0
    s_nop 1
    v_add_u32_dpp v41, v41, v41 row_shr:2 row_mask:0xf bank_mask:0xf bound_ctrl:0
    s_nop 1
    v_add_u32_dpp v41, v41, v41 row_shr:4 row_mask:0xf bank_mask:0xf bound_ctrl:0
    s_nop 1
    v_add_u32_dpp v41, v41, v41 row_shr:8 row_mask:0xf bank_mask:0xf bound_ctrl:0
    s_nop 1
    v_add_u32_dpp v41, v41, v41 row_bcast:15 row_mask:0xa bank_mask:0xf
    s_nop 1
    v_add_u32_dpp v41, v41, v41 row_bcast:31 row_mask:0xc bank_mask:0xf
    v_sub_u32 v36, v41, v40
    v_add_u32 v37, v36, v32
    v_add_u32 v38, v36, v38
    v_add_u32 v39, v36, v39
    v_lshlrev_b32 v40, 4, v36
    v_lshlrev_b32 v41, 4, v37
    v_lshlrev_b32 v42, 4, v38
    v_lshlrev_b32 v43, 4, v39
    ds_write_b128 v1, v[40:43] offset:26624
    v_lshl_or_b32 v32, v32, 16, v36
    v_lshl_or_b32 v33, v33, 16, v37
    v_lshl_or_b32 v34, v34, 16, v38
    v_lshl_or_b32 v35, v35, 16, v39
    global_store_dwordx4 v44, v[32:35], s[6:7] sc0 sc1
    s_waitcnt lgkmcnt(0)
K1_NOSCAN:
    s_barrier
    ds_read_b32 v20, v24 offset:26624
    ds_read_b32 v21, v25 offset:26624
    ds_read_b32 v22, v26 offset:26624
    ds_read_b32 v23, v27 offset:26624
    s_waitcnt lgkmcnt(3)
    v_add_u32 v46, v46, v20
    v_add_u32 v50, v50, v20
    ds_write_b32 v46, v12 offset:1024
    ds_write_b8 v50, v8 offset:1036
    s_waitcnt lgkmcnt(4)
    v_add_u32 v47, v47, v21
    v_add_u32 v51, v51, v21
    ds_write_b32 v47, v13 offset:1024
    ds_write_b8 v51, v9 offset:1036
    s_waitcnt lgkmcnt(5)
    v_add_u32 v48, v48, v22
    v_add_u32 v52, v52, v22
    ds_write_b32 v48, v14 offset:1024
    ds_write_b8 v52, v10 offset:1036
    s_waitcnt lgkmcnt(6)
    v_add_u32 v49, v49, v23
    v_add_u32 v53, v53, v23
    ds_write_b32 v49, v15 offset:1024
    ds_write_b8 v53, v11 offset:1036
    s_waitcnt lgkmcnt(0)
    s_barrier
    ds_read_b128 v[4:7], v1 offset:1024
    ds_read_b128 v[8:11], v1 offset:13824
    v_cmp_gt_u32 vcc, 440, v0
    s_waitcnt lgkmcnt(1)
    global_store_dwordx4 v2, v[4:7], s[6:7] sc0 sc1
    s_and_saveexec_b64 s[16:17], vcc
    s_cbranch_execz K1_END
    s_waitcnt lgkmcnt(0)
    global_store_dwordx4 v3, v[8:11], s[6:7] sc0 sc1
K1_END:
    s_endpgm
K1_W:
    s_cmp_ge_u32 s2, 255
    s_cbranch_scc1 K1_X
    v_cmp_gt_u32 vcc, 512, v0
    s_and_saveexec_b64 s[16:17], vcc
    s_cbranch_execz K1_X
    s_sub_u32 s3, s2, 250
    s_lshl_b32 s12, s3, 2
    s_lshr_b32 s13, 0x64785, s12
    s_and_b32 s13, s13, 15
    s_lshl_b32 s13, s13, 3
    s_load_dwordx2 s[4:5], s[0:1], s13
    s_load_dwordx2 s[6:7], s[0:1], 88
    v_and_b32 v1, 3, v0
    v_bfe_u32 v2, v0, 3, 2
    v_lshl_add_u32 v1, v2, 2, v1
    v_bfe_u32 v2, v0, 2, 1
    v_lshl_add_u32 v1, v2, 5, v1
    v_bfe_u32 v3, v0, 5, 1
    s_mov_b32 s14, 1.0
    s_bitcmp1_b32 9, s3
    s_cselect_b32 s14, 0xbfb8aa3b, s14
    s_cmp_eq_u32 s3, 4
    s_cbranch_scc1 K1_EXT
    v_lshrrev_b32 v2, 8, v0
    v_lshl_add_u32 v1, v2, 4, v1
    v_bfe_u32 v2, v0, 6, 2
    v_lshl_add_u32 v2, v3, 2, v2
    v_lshlrev_b32 v2, 10, v2
    v_lshl_add_u32 v1, v1, 1, v2
    s_lshl_b32 s12, s3, 13
    s_add_u32 s12, s12, 5505024
    v_lshl_add_u32 v4, v0, 4, s12
    s_waitcnt lgkmcnt(0)
    global_load_ushort v8, v1, s[4:5] offset:0
    global_load_ushort v9, v1, s[4:5] offset:128
    global_load_ushort v10, v1, s[4:5] offset:256
    global_load_ushort v11, v1, s[4:5] offset:384
    global_load_ushort v12, v1, s[4:5] offset:512
    global_load_ushort v13, v1, s[4:5] offset:640
    global_load_ushort v14, v1, s[4:5] offset:768
    global_load_ushort v15, v1, s[4:5] offset:896
    s_waitcnt vmcnt(0)
    v_lshlrev_b32 v8, 16, v8
    v_mul_f32 v8, s14, v8
    v_lshlrev_b32 v9, 16, v9
    v_mul_f32 v9, s14, v9
    v_lshlrev_b32 v10, 16, v10
    v_mul_f32 v10, s14, v10
    v_lshlrev_b32 v11, 16, v11
    v_mul_f32 v11, s14, v11
    v_lshlrev_b32 v12, 16, v12
    v_mul_f32 v12, s14, v12
    v_lshlrev_b32 v13, 16, v13
    v_mul_f32 v13, s14, v13
    v_lshlrev_b32 v14, 16, v14
    v_mul_f32 v14, s14, v14
    v_lshlrev_b32 v15, 16, v15
    v_mul_f32 v15, s14, v15
    v_cvt_pk_bf16_f32 v16, v8, v9
    v_cvt_pk_bf16_f32 v17, v10, v11
    v_cvt_pk_bf16_f32 v18, v12, v13
    v_cvt_pk_bf16_f32 v19, v14, v15
    global_store_dwordx4 v4, v[16:19], s[6:7]
    s_endpgm
K1_EXT:
    v_readfirstlane_b32 s12, v0
    s_cmp_ge_u32 s12, 256
    s_cbranch_scc1 K1_TAB
    s_cmp_eq_u32 s12, 128
    s_cbranch_scc1 K1_IDF
    v_cmp_gt_u32 vcc, 128, v0
    s_and_saveexec_b64 s[16:17], vcc
    s_cbranch_execz K1_X
    v_lshrrev_b32 v2, 6, v0
    v_lshl_add_u32 v1, v2, 4, v1
    v_lshlrev_b32 v1, 1, v1
    s_mov_b32 s12, 5537792
    v_lshl_add_u32 v4, v0, 2, s12
    s_waitcnt lgkmcnt(0)
    global_load_ushort v8, v1, s[4:5]
    s_waitcnt vmcnt(0)
    v_lshlrev_b32 v8, 16, v8
    v_mul_f32 v8, 0xbfb8aa3b, v8
    v_mov_b32 v12, 0
    v_cvt_pk_bf16_f32 v9, v12, v8
    v_sub_f32 v10, v8, v9
    v_cvt_pk_bf16_f32 v10, v12, v10
    v_or_b32 v9, 0x7000, v9
    v_cmp_eq_u32 vcc, 0, v3
    s_nop 1
    v_cndmask_b32 v9, v10, v9, vcc
    global_store_dword v4, v9, s[6:7]
K1_X:
    s_endpgm
K1_TAB:
    v_and_b32 v1, 255, v0
    v_mov_b32 v2, v1
    v_mov_b32 v5, 32
    v_cmp_le_u32 vcc, 8, v1
    v_add_u32 v3, 24, v2
    v_mov_b32 v4, 64
    v_cndmask_b32 v2, v2, v3, vcc
    v_cndmask_b32 v5, v5, v4, vcc
    v_cmp_le_u32 vcc, 20, v1
    v_add_u32 v3, 20, v2
    v_mov_b32 v4, 64
    v_cndmask_b32 v2, v2, v3, vcc
    v_cndmask_b32 v5, v5, v4, vcc
    v_cmp_le_u32 vcc, 32, v1
    v_add_u32 v3, 20, v2
    v_mov_b32 v4, 64
    v_cndmask_b32 v2, v2, v3, vcc
    v_cndmask_b32 v5, v5, v4, vcc
    v_cmp_le_u32 vcc, 44, v1
    v_add_u32 v3, 20, v2
    v_mov_b32 v4, 128
    v_cndmask_b32 v2, v2, v3, vcc
    v_cndmask_b32 v5, v5, v4, vcc
    v_cmp_le_u32 vcc, 172, v1
    v_add_u32 v3, 4294967084, v2
    v_mov_b32 v4, 128
    v_cndmask_b32 v2, v2, v3, vcc
    v_cndmask_b32 v5, v5, v4, vcc
    v_cmp_le_u32 vcc, 176, v1
    v_add_u32 v3, 12, v2
    v_mov_b32 v4, 128
    v_cndmask_b32 v2, v2, v3, vcc
    v_cndmask_b32 v5, v5, v4, vcc
    v_cmp_le_u32 vcc, 180, v1
    v_add_u32 v3, 12, v2
    v_mov_b32 v4, 128
    v_cndmask_b32 v2, v2, v3, vcc
    v_cndmask_b32 v5, v5, v4, vcc
    v_cmp_le_u32 vcc, 184, v1
    v_add_u32 v3, 12, v2
    v_mov_b32 v4, 128
    v_cndmask_b32 v2, v2, v3, vcc
    v_cndmask_b32 v5, v5, v4, vcc
    v_cmp_le_u32 vcc, 188, v1
    v_add_u32 v3, 12, v2
    v_mov_b32 v4, 128
    v_cndmask_b32 v2, v2, v3, vcc
    v_cndmask_b32 v5, v5, v4, vcc
    v_cmp_le_u32 vcc, 192, v1
    v_add_u32 v3, 12, v2
    v_mov_b32 v4, 128
    v_cndmask_b32 v2, v2, v3, vcc
    v_cndmask_b32 v5, v5, v4, vcc
    v_cmp_le_u32 vcc, 196, v1
    v_add_u32 v3, 0, v2
    v_mov_b32 v4, 0
    v_cndmask_b32 v2, v2, v3, vcc
    v_cndmask_b32 v5, v5, v4, vcc
    v_lshrrev_b32 v3, 5, v2
    v_and_b32 v2, 31, v2
    v_lshlrev_b32 v3, 12, v3
    v_lshl_add_u32 v4, v2, 2, v3
    v_add_u32 v4, 8320, v4
    v_mov_b32 v3, 1536
    v_cndmask_b32 v4, v4, v3, vcc
    v_lshl_or_b32 v4, v5, 16, v4
    s_mov_b32 s12, 5539840
    v_lshl_add_u32 v1, v1, 2, s12
    s_waitcnt lgkmcnt(0)
    global_store_dword v1, v4, s[6:7]
    s_endpgm
K1_IDF:
    v_bfe_u32 v1, v0, 3, 1
    v_bfe_u32 v4, v0, 1, 1
    v_lshl_add_u32 v1, v1, 1, v4
    v_xor_b32 v2, v2, v3
    v_lshl_add_u32 v1, v2, 2, v1
    v_and_b32 v4, 1, v0
    v_lshlrev_b32 v4, 4, v4
    v_mov_b32 v5, 0x3f80
    v_lshlrev_b32 v4, v4, v5
    v_cmp_eq_u32 vcc, 0, v1
    s_nop 1
    v_cndmask_b32 v8, 0, v4, vcc
    v_cmp_eq_u32 vcc, 1, v1
    s_nop 1
    v_cndmask_b32 v9, 0, v4, vcc
    v_cmp_eq_u32 vcc, 2, v1
    s_nop 1
    v_cndmask_b32 v10, 0, v4, vcc
    v_cmp_eq_u32 vcc, 3, v1
    s_nop 1
    v_cndmask_b32 v11, 0, v4, vcc
    s_mov_b32 s12, 5536768
    v_lshl_add_u32 v1, v0, 4, s12
    s_waitcnt lgkmcnt(0)
    global_store_dwordx4 v1, v[8:11], s[6:7]
    s_endpgm
.globl gather_scatter__edge_featured_mpnn_gatedgcn__graph_kernel
.p2align 8
.type gather_scatter__edge_featured_mpnn_gatedgcn__graph_kernel,@function
gather_scatter__edge_featured_mpnn_gatedgcn__graph_kernel:
    s_cmp_ge_u32 s2, 256
    s_cbranch_scc1 K2_X
    s_load_dwordx2 s[8:9], s[0:1], 88
    s_load_dwordx2 s[4:5], s[0:1], 0
    s_load_dwordx2 s[6:7], s[0:1], 72
    s_and_b32 s3, s2, 7
    s_lshl_b32 s28, s3, 5
    s_lshr_b32 s3, s2, 3
    s_add_u32 s28, s28, s3
    v_lshrrev_b32 v11, 6, v0
    v_lshrrev_b32 v12, 3, v0
    v_readfirstlane_b32 s29, v11
    v_lshlrev_b32 v13, 10, v12
    v_and_b32 v9, 63, v0
    v_lshlrev_b32 v14, 4, v9
    s_lshl_b32 s42, s28, 2
    s_add_u32 s43, s42, 65536
    s_add_u32 s44, s42, 131072
    s_add_u32 s45, s42, 196608
    s_lshl_b32 s46, s29, 12
    s_cmp_ge_u32 s29, 6
    s_cselect_b32 s47, 4096, 0
    s_add_u32 s47, s47, 40960
    s_add_u32 m0, s46, s47
    s_add_u32 s46, s46, 5505024
    s_mov_b32 s47, 5537792
    v_lshlrev_b32 v15, 2, v9
    v_mov_b32 v232, 0
    v_lshlrev_b32 v233, 2, v0
    ds_write_b32 v233, v232
    s_mov_b32 s26, 256000
    s_mov_b32 s27, 0x20000
    s_waitcnt lgkmcnt(0)
    s_add_u32 s24, s8, 5242880
    s_addc_u32 s25, s9, 0
    buffer_load_dword v240, v13, s[24:27], s42 offen
    buffer_load_dword v241, v13, s[24:27], s43 offen
    buffer_load_dword v242, v13, s[24:27], s44 offen
    buffer_load_dword v243, v13, s[24:27], s45 offen
    s_barrier
    s_mov_b32 s20, s8
    s_mov_b32 s21, s9
    s_mov_b32 s22, 16777216
    s_mov_b32 s23, 0x20000
    buffer_load_dwordx4 v14, s[20:23], s46 offen offset:0 lds
    buffer_load_dwordx4 v14, s[20:23], s46 offen offset:1024 lds
    buffer_load_dwordx4 v14, s[20:23], s46 offen offset:2048 lds
    buffer_load_dwordx4 v14, s[20:23], s46 offen offset:3072 lds
    buffer_load_dword v16, v15, s[20:23], s47 offen
    buffer_load_dword v18, v15, s[20:23], s47 offen offset:256
    s_and_b32 s46, s29, 3
    s_lshl_b32 s46, s46, 10
    s_add_u32 m0, s46, 2048
    s_add_u32 s47, s47, s46
    buffer_load_dwordx4 v14, s[20:23], s47 offen offset:1024 lds
    s_mov_b32 s12, s4
    s_mov_b32 s13, s5
    s_mov_b32 s14, 6400000
    s_mov_b32 s15, 0x20000
    s_sub_u32 s16, s6, 3072
    s_subb_u32 s17, s7, 0
    s_mov_b32 s18, 6403072
    s_mov_b32 s19, 0x20000
    s_sub_u32 s60, s4, 3072
    s_subb_u32 s61, s5, 0
    s_mov_b32 s62, 6403072
    s_mov_b32 s63, 0x20000
    v_lshlrev_b32 v11, 4, v0
    v_mov_b32 v228, 0xffff
    v_mov_b32 v229, 0xffff
    v_mov_b32 v230, 0xffff
    v_mov_b32 v231, 0xffff
    ds_write_b128 v11, v[228:231] offset:8192
    ds_write_b128 v11, v[228:231] offset:16384
    ds_write_b128 v11, v[228:231] offset:24576
    ds_write_b128 v11, v[228:231] offset:32768
    v_mov_b32 v10, 1
    v_mov_b32 v17, 0
    v_mov_b32 v19, 0
    v_mov_b32 v245, 0
    v_mov_b32 v246, 0
    v_mov_b32 v247, 0
    s_movk_i32 s36, 128
    s_mov_b32 s37, 50000
    s_mul_i32 s32, s28, 196
    s_sub_u32 s33, 50000, s32
    s_min_u32 s33, s33, 196
    s_lshl_b32 s3, s29, 2
    s_lshr_b32 s30, 0x12307654, s3
    s_and_b32 s30, s30, 7
    s_mul_i32 s35, s29, 12288
    s_add_u32 s35, s35, 65536
    v_lshrrev_b32 v228, 5, v9
    v_bfe_u32 v229, v9, 4, 1
    v_lshl_or_b32 v228, v229, 1, v228
    v_and_b32 v230, 7, v9
    v_xor_b32 v228, v228, v230
    v_lshlrev_b32 v1, 4, v228
    v_xor_b32 v2, 64, v1
    v_and_b32 v231, 2, v9
    v_or_b32 v231, v231, v229
    v_and_b32 v232, 1, v9
    v_lshl_or_b32 v231, v232, 2, v231
    v_bfe_u32 v232, v9, 2, 2
    v_lshl_add_u32 v233, v231, 2, v232
    v_lshlrev_b32 v231, 7, v231
    v_lshl_add_u32 v231, v232, 10, v231
    v_add_u32 v231, s35, v231
    v_lshrrev_b32 v232, 5, v9
    v_lshlrev_b32 v232, 2, v232
    v_xor_b32 v232, v232, v230
    v_xor_b32 v234, 0, v232
    v_lshl_add_u32 v3, v234, 4, v231
    v_xor_b32 v234, 1, v232
    v_lshl_add_u32 v4, v234, 4, v231
    v_xor_b32 v234, 2, v232
    v_lshl_add_u32 v5, v234, 4, v231
    v_xor_b32 v234, 3, v232
    v_lshl_add_u32 v6, v234, 4, v231
    s_lshl_b32 s3, s30, 12
    v_lshl_add_u32 v8, v233, 2, s3
    v_lshrrev_b32 v233, 3, v9
    v_lshl_add_u32 v7, v233, 4, s3
    v_mul_u32_u24 v12, 19840, v12
    v_lshl_add_u32 v12, v230, 4, v12
    v_add_u32 v231, 8, v230
    v_bfrev_b32 v232, 1
    s_mov_b32 s43, 1269760
    s_mov_b32 s44, 2539520
    s_mov_b32 s45, 3809280
    s_waitcnt vmcnt(7)
    v_cmp_lt_u32_sdwa s[92:93], v230, v240 src0_sel:DWORD src1_sel:WORD_1
    v_mad_u32_u16 v234, v240, 16, v12
    v_cmp_lt_u32_sdwa s[94:95], v230, v241 src0_sel:DWORD src1_sel:WORD_1
    v_mad_u32_u16 v235, v241, 16, v12
    v_cndmask_b32 v233, v232, v234, s[92:93]
    buffer_load_dwordx4 v[148:151], v233, s[20:23], 0 offen
    v_cmp_lt_u32_sdwa s[96:97], v230, v242 src0_sel:DWORD src1_sel:WORD_1
    v_mad_u32_u16 v236, v242, 16, v12
    v_cndmask_b32 v233, v232, v235, s[94:95]
    buffer_load_dwordx4 v[152:155], v233, s[20:23], s43 offen
    v_cmp_lt_u32_sdwa s[98:99], v230, v243 src0_sel:DWORD src1_sel:WORD_1
    v_mad_u32_u16 v237, v243, 16, v12
    v_cndmask_b32 v233, v232, v236, s[96:97]
    buffer_load_dwordx4 v[156:159], v233, s[20:23], s44 offen
    v_cndmask_b32 v233, v232, v237, s[98:99]
    buffer_load_dwordx4 v[160:163], v233, s[20:23], s45 offen
    v_max3_u32 v238, v240, v241, v242
    v_max_u32 v238, v238, v243
    v_cmp_lt_u32 vcc, 0x8ffff, v238
    s_mov_b32 s34, 0
    s_nop 2
    s_cbranch_vccnz K2_NOB0_O
K2_NOB0:
    v_cmpx_lt_u32 vcc, 0x10ffff, v238
    v_mov_b32 v232, 0
    ds_write_b32 v232, v10 offset:1280
    s_mov_b64 exec, -1
    v_mov_b64 v[84:85], 0
    v_mov_b64 v[86:87], 0
    v_mov_b64 v[88:89], 0
    v_mov_b64 v[90:91], 0
    v_mov_b64 v[92:93], 0
    v_mov_b64 v[94:95], 0
    v_mov_b64 v[96:97], 0
    v_mov_b64 v[98:99], 0
    v_mov_b64 v[100:101], 0
    v_mov_b64 v[102:103], 0
    v_mov_b64 v[104:105], 0
    v_mov_b64 v[106:107], 0
    v_mov_b64 v[108:109], 0
    v_mov_b64 v[110:111], 0
    v_mov_b64 v[112:113], 0
    v_mov_b64 v[114:115], 0
    v_mov_b32 v36, v14
    v_lshlrev_b32 v37, 2, v9
    v_sub_u32 v38, 252, v37
    v_mov_b32 v39, 0xffff
    v_mov_b32 v22, 1020
    v_add_u32 v240, -1, v37
    v_cmp_gt_u32 s[92:93], s33, v240
    v_add_u32 v240, s32, v240
    v_add_u32 v241, 0, v37
    v_cmp_gt_u32 s[94:95], s33, v241
    v_add_u32 v241, s32, v241
    v_add_u32 v242, 1, v37
    v_cmp_gt_u32 s[96:97], s33, v242
    v_add_u32 v242, s32, v242
    v_add_u32 v243, 2, v37
    v_cmp_gt_u32 s[98:99], s33, v243
    v_add_u32 v243, s32, v243
    v_add_u32 v238, 65536, v14
    s_lshl_b32 s42, s30, 7
    s_sub_u32 s42, s42, 336
    s_mul_i32 s43, s30, 48
    s_sub_u32 s43, s43, 16
    s_cmp_lt_u32 s30, 4
    s_cselect_b32 s42, s43, s42
    s_cselect_b32 s39, 1, 0
    s_cselect_b32 s45, 0x30, -1
    s_cmp_eq_u32 s30, 0
    s_cselect_b32 s42, 0, s42
    s_cselect_b32 s39, 2, s39
    s_lshr_b32 s43, 0x70, s39
    s_and_b32 s43, s43, 0x70
    s_lshl_b32 s44, s30, 5
    s_add_u32 s44, s44, 656
    v_and_b32 v11, s43, v7
    v_cmp_eq_u32 vcc, s45, v11
    v_bfe_u32 v13, v7, 6, 1
    v_lshl_add_u32 v13, v13, 4, s44
    v_add_u32 v11, s42, v11
    v_cndmask_b32 v11, v11, v13, vcc
    s_andn2_b32 s44, 0x70, s43
    v_and_b32 v13, s44, v7
    v_cmp_eq_u32 s[52:53], 0, v13
    v_and_b32 v13, s43, v8
    s_or_b64 s[52:53], s[52:53], vcc
    v_cmp_ne_u32 s[54:55], s45, v13
    v_mov_b32 v13, 2048
    v_mov_b32 v239, -1
    s_movk_i32 s42, 2224
    s_movk_i32 s43, 1280
    s_mov_b32 s44, 3735551
    s_mov_b32 s45, 1900543
    v_writelane_b32 v13, s42, 1
    v_writelane_b32 v13, s43, 2
    v_writelane_b32 v239, s44, 0
    v_writelane_b32 v239, s45, 1
    v_writelane_b32 v239, 0, 2
    v_add_u32 v14, 1024, v1
    v_mov_b32 v15, v2
    v_add_u32 v1, 3072, v1
    v_add_u32 v2, 2048, v2
    s_lshl_b32 s42, s39, 23
    s_sub_u32 s42, 0x358637bd, s42
    v_mov_b32 v228, 0x358637bd
    v_mov_b32 v229, s42
    v_cndmask_b32 v116, v228, v229, s[54:55]
    v_mov_b32 v117, v116
    v_mov_b64 v[118:119], v[116:117]
    v_mov_b64 v[120:121], v[116:117]
    v_mov_b64 v[122:123], v[116:117]
    v_mov_b64 v[124:125], v[116:117]
    v_mov_b64 v[126:127], v[116:117]
    v_mov_b64 v[128:129], v[116:117]
    v_mov_b64 v[130:131], v[116:117]
    v_mov_b64 v[132:133], v[116:117]
    v_mov_b64 v[134:135], v[116:117]
    v_mov_b64 v[136:137], v[116:117]
    v_mov_b64 v[138:139], v[116:117]
    v_mov_b64 v[140:141], v[116:117]
    v_mov_b64 v[142:143], v[116:117]
    v_mov_b64 v[144:145], v[116:117]
    v_mov_b64 v[146:147], v[116:117]
    s_mov_b32 s38, 0
    v_mov_b32 v164, 0x40000
    v_mov_b32 v165, v164
    v_mov_b64 v[166:167], v[164:165]
    v_mov_b64 v[168:169], v[164:165]
    v_mov_b64 v[170:171], v[164:165]
    v_mov_b64 v[172:173], v[164:165]
    v_mov_b64 v[174:175], v[164:165]
    s_waitcnt vmcnt(3)
    v_lshlrev_b32_sdwa v176, 2, v151 dst_sel:DWORD dst_unused:UNUSED_PAD src0_sel:DWORD src1_sel:BYTE_0
    v_lshlrev_b32_sdwa v177, 2, v151 dst_sel:DWORD dst_unused:UNUSED_PAD src0_sel:DWORD src1_sel:BYTE_1
    v_lshlrev_b32_sdwa v178, 2, v151 dst_sel:DWORD dst_unused:UNUSED_PAD src0_sel:DWORD src1_sel:BYTE_2
    v_cmpx_ne_u32 vcc, 0, v176
    ds_add_rtn_u32 v164, v176, v10 offset:0
    v_cmpx_ne_u32 vcc, 0, v177
    ds_add_rtn_u32 v165, v177, v10 offset:0
    v_cmpx_ne_u32 vcc, 0, v178
    ds_add_rtn_u32 v166, v178, v10 offset:0
    s_mov_b64 exec, -1
    s_waitcnt vmcnt(2)
    v_lshlrev_b32_sdwa v179, 2, v155 dst_sel:DWORD dst_unused:UNUSED_PAD src0_sel:DWORD src1_sel:BYTE_0
    v_lshlrev_b32_sdwa v180, 2, v155 dst_sel:DWORD dst_unused:UNUSED_PAD src0_sel:DWORD src1_sel:BYTE_1
    v_lshlrev_b32_sdwa v181, 2, v155 dst_sel:DWORD dst_unused:UNUSED_PAD src0_sel:DWORD src1_sel:BYTE_2
    v_cmpx_ne_u32 vcc, 0, v179
    ds_add_rtn_u32 v167, v179, v10 offset:0
    v_cmpx_ne_u32 vcc, 0, v180
    ds_add_rtn_u32 v168, v180, v10 offset:0
    v_cmpx_ne_u32 vcc, 0, v181
    ds_add_rtn_u32 v169, v181, v10 offset:0
    s_mov_b64 exec, -1
    s_waitcnt vmcnt(1)
    v_lshlrev_b32_sdwa v182, 2, v159 dst_sel:DWORD dst_unused:UNUSED_PAD src0_sel:DWORD src1_sel:BYTE_0
    v_lshlrev_b32_sdwa v183, 2, v159 dst_sel:DWORD dst_unused:UNUSED_PAD src0_sel:DWORD src1_sel:BYTE_1
    v_lshlrev_b32_sdwa v184, 2, v159 dst_sel:DWORD dst_unused:UNUSED_PAD src0_sel:DWORD src1_sel:BYTE_2
    v_cmpx_ne_u32 vcc, 0, v182
    ds_add_rtn_u32 v170, v182, v10 offset:0
    v_cmpx_ne_u32 vcc, 0, v183
    ds_add_rtn_u32 v171, v183, v10 offset:0
    v_cmpx_ne_u32 vcc, 0, v184
    ds_add_rtn_u32 v172, v184, v10 offset:0
    s_mov_b64 exec, -1
    s_waitcnt vmcnt(0)
    v_lshlrev_b32_sdwa v185, 2, v163 dst_sel:DWORD dst_unused:UNUSED_PAD src0_sel:DWORD src1_sel:BYTE_0
    v_lshlrev_b32_sdwa v186, 2, v163 dst_sel:DWORD dst_unused:UNUSED_PAD src0_sel:DWORD src1_sel:BYTE_1
    v_lshlrev_b32_sdwa v187, 2, v163 dst_sel:DWORD dst_unused:UNUSED_PAD src0_sel:DWORD src1_sel:BYTE_2
    v_cmpx_ne_u32 vcc, 0, v185
    ds_add_rtn_u32 v173, v185, v10 offset:0
    v_cmpx_ne_u32 vcc, 0, v186
    ds_add_rtn_u32 v174, v186, v10 offset:0
    v_cmpx_ne_u32 vcc, 0, v187
    ds_add_rtn_u32 v175, v187, v10 offset:0
    s_mov_b64 exec, -1
    s_cmp_eq_u32 s34, 0
    s_cbranch_scc0 K2_NOB1_O
K2_NOB1:
    s_waitcnt lgkmcnt(0)
    s_barrier
    s_cmp_lg_u32 s29, 0
    s_cbranch_scc1 K2_RPF
    ds_read_b128 v[228:231], v36 offset:0
    s_waitcnt lgkmcnt(0)
    v_min_u32 v232, 62, v228
    v_lshl_add_u32 v232, v232, 2, 4
    v_cndmask_b32 v232, 0, v232, s[92:93]
    ds_add_rtn_u32 v32, v232, v10 offset:1024
    v_min_u32 v233, 62, v229
    v_lshl_add_u32 v233, v233, 2, 4
    v_cndmask_b32 v233, 0, v233, s[94:95]
    ds_add_rtn_u32 v33, v233, v10 offset:1024
    v_min_u32 v234, 62, v230
    v_lshl_add_u32 v234, v234, 2, 4
    v_cndmask_b32 v234, 0, v234, s[96:97]
    ds_add_rtn_u32 v34, v234, v10 offset:1024
    v_min_u32 v235, 62, v231
    v_lshl_add_u32 v235, v235, 2, 4
    v_cndmask_b32 v235, 0, v235, s[98:99]
    ds_add_rtn_u32 v35, v235, v10 offset:1024
    ds_read_b32 v20, v38 offset:1024
    v_sub_u32 v232, 252, v232
    v_lshl_or_b32 v240, v228, 16, v240
    v_cndmask_b32 v240, v39, v240, s[92:93]
    v_sub_u32 v233, 252, v233
    v_lshl_or_b32 v241, v229, 16, v241
    v_cndmask_b32 v241, v39, v241, s[94:95]
    v_sub_u32 v234, 252, v234
    v_lshl_or_b32 v242, v230, 16, v242
    v_cndmask_b32 v242, v39, v242, s[96:97]
    v_sub_u32 v235, 252, v235
    v_lshl_or_b32 v243, v231, 16, v243
    v_cndmask_b32 v243, v39, v243, s[98:99]
    s_waitcnt lgkmcnt(0)
    v_mov_b32 v21, v20
    s_nop 1
    v_add_u32_dpp v21, v21, v21 row_shr:1 row_mask:0xf bank_mask:0xf bound_ctrl:0
    s_nop 1
    v_add_u32_dpp v21, v21, v21 row_shr:2 row_mask:0xf bank_mask:0xf bound_ctrl:0
    s_nop 1
    v_add_u32_dpp v21, v21, v21 row_shr:4 row_mask:0xf bank_mask:0xf bound_ctrl:0
    s_nop 1
    v_add_u32_dpp v21, v21, v21 row_shr:8 row_mask:0xf bank_mask:0xf bound_ctrl:0
    s_nop 1
    v_add_u32_dpp v21, v21, v21 row_bcast:15 row_mask:0xa bank_mask:0xf
    s_nop 1
    v_add_u32_dpp v21, v21, v21 row_bcast:31 row_mask:0xc bank_mask:0xf
    v_sub_u32 v21, v21, v20
    ds_bpermute_b32 v232, v232, v21
    ds_bpermute_b32 v233, v233, v21
    ds_bpermute_b32 v234, v234, v21
    ds_bpermute_b32 v235, v235, v21
    s_waitcnt lgkmcnt(3)
    v_add_lshl_u32 v232, v232, v32, 2
    v_cndmask_b32 v32, v22, v232, s[92:93]
    ds_read_b32 v24, v32 offset:4096
    s_waitcnt lgkmcnt(3)
    v_add_lshl_u32 v233, v233, v33, 2
    v_cndmask_b32 v33, v22, v233, s[94:95]
    ds_read_b32 v25, v33 offset:4096
    s_waitcnt lgkmcnt(3)
    v_add_lshl_u32 v234, v234, v34, 2
    v_cndmask_b32 v34, v22, v234, s[96:97]
    ds_read_b32 v26, v34 offset:4096
    s_waitcnt lgkmcnt(3)
    v_add_lshl_u32 v235, v235, v35, 2
    v_cndmask_b32 v35, v22, v235, s[98:99]
    ds_read_b32 v27, v35 offset:4096
    ds_write_b32 v232, v240 offset:2048
    ds_write_b32 v233, v241 offset:2048
    ds_write_b32 v234, v242 offset:2048
    ds_write_b32 v235, v243 offset:2048
    s_waitcnt lgkmcnt(4)
    ds_write_b128 v36, v[24:27] offset:6144
    s_waitcnt lgkmcnt(0)
    s_branch K2_NOSORT
K2_RPF:
    v_cmpx_gt_u32 vcc, 1, v164
    v_mad_u32_u16 v228, v148, s36, 0
    buffer_load_dword v255, v228, s[12:15], 0 offen
    s_mov_b64 exec, -1
    v_cmpx_gt_u32 vcc, 1, v165
    v_mad_u32_u16 v229, v149, s36, 0
    buffer_load_dword v255, v229, s[12:15], 0 offen
    s_mov_b64 exec, -1
    v_cmpx_gt_u32 vcc, 1, v166
    v_mad_u32_u16 v230, v150, s36, 0
    buffer_load_dword v255, v230, s[12:15], 0 offen
    s_mov_b64 exec, -1
    v_cmpx_gt_u32 vcc, 1, v167
    v_mad_u32_u16 v231, v152, s36, 0
    buffer_load_dword v255, v231, s[12:15], 0 offen
    s_mov_b64 exec, -1
    v_cmpx_gt_u32 vcc, 1, v168
    v_mad_u32_u16 v228, v153, s36, 0
    buffer_load_dword v255, v228, s[12:15], 0 offen
    s_mov_b64 exec, -1
    v_cmpx_gt_u32 vcc, 1, v169
    v_mad_u32_u16 v229, v154, s36, 0
    buffer_load_dword v255, v229, s[12:15], 0 offen
    s_mov_b64 exec, -1
    v_cmpx_gt_u32 vcc, 1, v170
    v_mad_u32_u16 v230, v156, s36, 0
    buffer_load_dword v255, v230, s[12:15], 0 offen
    s_mov_b64 exec, -1
    v_cmpx_gt_u32 vcc, 1, v171
    v_mad_u32_u16 v231, v157, s36, 0
    buffer_load_dword v255, v231, s[12:15], 0 offen
    s_mov_b64 exec, -1
    v_cmpx_gt_u32 vcc, 1, v172
    v_mad_u32_u16 v228, v158, s36, 0
    buffer_load_dword v255, v228, s[12:15], 0 offen
    s_mov_b64 exec, -1
    v_cmpx_gt_u32 vcc, 1, v173
    v_mad_u32_u16 v229, v160, s36, 0
    buffer_load_dword v255, v229, s[12:15], 0 offen
    s_mov_b64 exec, -1
    v_cmpx_gt_u32 vcc, 1, v174
    v_mad_u32_u16 v230, v161, s36, 0
    buffer_load_dword v255, v230, s[12:15], 0 offen
    s_mov_b64 exec, -1
    v_cmpx_gt_u32 vcc, 1, v175
    v_mad_u32_u16 v231, v162, s36, 0
    buffer_load_dword v255, v231, s[12:15], 0 offen
    s_mov_b64 exec, -1
K2_NOSORT:
    s_barrier
    ds_read_b128 v[248:251], v11 offset:2048
    ds_read_b32 v228, v13
    ds_read_b32 v176, v176 offset:6144
    ds_read_b32 v177, v177 offset:6144
    ds_read_b32 v178, v178 offset:6144
    ds_read_b32 v179, v179 offset:6144
    ds_read_b32 v180, v180 offset:6144
    ds_read_b32 v181, v181 offset:6144
    ds_read_b32 v182, v182 offset:6144
    ds_read_b32 v183, v183 offset:6144
    ds_read_b32 v184, v184 offset:6144
    ds_read_b32 v185, v185 offset:6144
    ds_read_b32 v186, v186 offset:6144
    ds_read_b32 v187, v187 offset:6144
    s_waitcnt lgkmcnt(12)
    v_cmp_gt_u32 vcc, v228, v239
    v_readfirstlane_b32 s45, v248
    s_add_u32 m0, s35, 0
    v_mad_u32_u16 v253, v250, s36, v14
    v_mad_u32_u16 v254, v251, s36, v15
    s_cbranch_vccnz K2_SLOW
    v_mad_u32_u16 v12, v248, s36, v1
    buffer_load_dwordx4 v253, s[60:63], 0 offen offset:2048 lds
    v_mad_u32_u16 v13, v249, s36, v2
    buffer_load_dwordx4 v254, s[60:63], 0 offen offset:3072 lds
    buffer_load_dwordx4 v12, s[60:63], 0 offen offset:0 lds
    buffer_load_dwordx4 v13, s[60:63], 0 offen offset:1024 lds
    s_waitcnt lgkmcnt(10)
    v_mad_u16 v164, v164, v176, v176 op_sel:[0,1,0,0]
    ds_write_b32 v164, v148
    v_mad_u16 v165, v165, v177, v177 op_sel:[0,1,0,0]
    ds_write_b32 v165, v149
    s_waitcnt lgkmcnt(10)
    v_mad_u16 v166, v166, v178, v178 op_sel:[0,1,0,0]
    ds_write_b32 v166, v150
    v_mad_u16 v167, v167, v179, v179 op_sel:[0,1,0,0]
    ds_write_b32 v167, v152
    s_waitcnt lgkmcnt(10)
    v_mad_u16 v168, v168, v180, v180 op_sel:[0,1,0,0]
    ds_write_b32 v168, v153
    v_mad_u16 v169, v169, v181, v181 op_sel:[0,1,0,0]
    ds_write_b32 v169, v154
    s_waitcnt lgkmcnt(10)
    v_mad_u16 v170, v170, v182, v182 op_sel:[0,1,0,0]
    ds_write_b32 v170, v156
    v_mad_u16 v171, v171, v183, v183 op_sel:[0,1,0,0]
    ds_write_b32 v171, v157
    s_waitcnt lgkmcnt(10)
    v_mad_u16 v172, v172, v184, v184 op_sel:[0,1,0,0]
    ds_write_b32 v172, v158
    v_mad_u16 v173, v173, v185, v185 op_sel:[0,1,0,0]
    ds_write_b32 v173, v160
    s_waitcnt lgkmcnt(10)
    v_mad_u16 v174, v174, v186, v186 op_sel:[0,1,0,0]
    ds_write_b32 v174, v161
    v_mad_u16 v175, v175, v187, v187 op_sel:[0,1,0,0]
    ds_write_b32 v175, v162
    s_lshr_b32 s45, s45, 16
    s_lshl_b32 s46, 1, s39
    s_add_u32 s45, s45, s46
    s_sub_u32 s45, s45, 1
    s_lshr_b32 s31, s45, s39
    v_readlane_b32 s45, v248, 24
    s_lshr_b32 s45, s45, 16
    s_cmp_eq_u32 s39, 1
    s_cselect_b32 s45, s45, 0
    s_max_u32 s31, s31, s45
    s_lshl_b32 s45, s31, 7
    v_add_u32 v11, s45, v7
    ds_write_b128 v11, v[248:251] offset:8320
    s_cmp_eq_u32 s34, 0
    s_cbranch_scc0 K2_NOB2_O
K2_NOB2:
    ds_read_b128 v[196:199], v238 offset:4096
    ds_read_b128 v[200:203], v238 offset:5120
    ds_read_b128 v[204:207], v238 offset:6144
    ds_read_b128 v[208:211], v238 offset:7168
    ds_read_b128 v[212:215], v238 offset:8192
    ds_read_b128 v[216:219], v238 offset:9216
    ds_read_b128 v[220:223], v238 offset:10240
    ds_read_b128 v[224:227], v238 offset:11264
    s_waitcnt lgkmcnt(0)
    s_barrier
    ds_read_b128 v[180:183], v7 offset:8320
    ds_read_b128 v[184:187], v7 offset:8448
    ds_read_b128 v[188:191], v7 offset:8576
    ds_read_b32 v252, v8 offset:8320
    ds_read_b128 v[248:251], v7 offset:8704
    s_waitcnt lgkmcnt(4)
    s_add_u32 m0, s35, 4096
    v_mad_u32_u16 v180, v180, s36, v1
    buffer_load_dwordx4 v180, s[60:63], 0 offen offset:0 lds
    v_mad_u32_u16 v181, v181, s36, v2
    buffer_load_dwordx4 v181, s[60:63], 0 offen offset:1024 lds
    v_mad_u32_u16 v182, v182, s36, v14
    buffer_load_dwordx4 v182, s[60:63], 0 offen offset:2048 lds
    v_mad_u32_u16 v183, v183, s36, v15
    buffer_load_dwordx4 v183, s[60:63], 0 offen offset:3072 lds
    v_lshlrev_b32 v11, 4, v9
    ds_read_b128 v[20:23], v11 offset:40960
    ds_read_b128 v[24:27], v11 offset:41984
    ds_read_b128 v[28:31], v11 offset:43008
    ds_read_b128 v[32:35], v11 offset:44032
    ds_read_b128 v[36:39], v11 offset:45056
    ds_read_b128 v[40:43], v11 offset:46080
    ds_read_b128 v[44:47], v11 offset:47104
    ds_read_b128 v[48:51], v11 offset:48128
    ds_read_b128 v[52:55], v11 offset:49152
    ds_read_b128 v[56:59], v11 offset:50176
    ds_read_b128 v[60:63], v11 offset:51200
    ds_read_b128 v[64:67], v11 offset:52224
    ds_read_b128 v[68:71], v11 offset:53248
    ds_read_b128 v[72:75], v11 offset:54272
    ds_read_b128 v[76:79], v11 offset:55296
    ds_read_b128 v[80:83], v11 offset:56320
    s_waitcnt vmcnt(4)
    ds_read_b128 v[228:231], v3 offset:0
    ds_read_b128 v[232:235], v4 offset:0
    ds_read_b128 v[236:239], v5 offset:0
    ds_read_b128 v[240:243], v6 offset:0
    s_waitcnt lgkmcnt(0)
    v_mfma_f32_32x32x16_bf16 v[148:163], v[196:199], v[228:231], 0
    v_mfma_f32_32x32x16_bf16 v[148:163], v[200:203], v[232:235], v[148:163]
    v_mfma_f32_32x32x16_bf16 v[148:163], v[204:207], v[236:239], v[148:163]
    v_mfma_f32_32x32x16_bf16 v[148:163], v[208:211], v[240:243], v[148:163]
    v_mfma_f32_32x32x16_bf16 v[164:179], v[212:215], v[228:231], 0
    v_mfma_f32_32x32x16_bf16 v[164:179], v[216:219], v[232:235], v[164:179]
    v_mfma_f32_32x32x16_bf16 v[164:179], v[220:223], v[236:239], v[164:179]
    v_mfma_f32_32x32x16_bf16 v[164:179], v[224:227], v[240:243], v[164:179]
    s_add_u32 m0, s35, 8192
    v_mad_u32_u16 v184, v184, s36, v1
    buffer_load_dwordx4 v184, s[60:63], 0 offen offset:0 lds
    v_mad_u32_u16 v185, v185, s36, v2
    buffer_load_dwordx4 v185, s[60:63], 0 offen offset:1024 lds
    v_mad_u32_u16 v186, v186, s36, v14
    buffer_load_dwordx4 v186, s[60:63], 0 offen offset:2048 lds
    v_mad_u32_u16 v187, v187, s36, v15
    buffer_load_dwordx4 v187, s[60:63], 0 offen offset:3072 lds
    v_pk_sub_u16 v244, v252, s37 clamp
K2_PIPE:
    s_waitcnt vmcnt(4)
    ds_read_b128 v[228:231], v3 offset:4096
    ds_read_b128 v[232:235], v4 offset:4096
    ds_read_b128 v[236:239], v5 offset:4096
    ds_read_b128 v[240:243], v6 offset:4096
    s_add_u32 m0, s35, 0
    v_mad_u32_u16 v188, v188, s36, v1
    buffer_load_dwordx4 v188, s[60:63], 0 offen offset:0 lds
    v_mad_u32_u16 v189, v189, s36, v2
    buffer_load_dwordx4 v189, s[60:63], 0 offen offset:1024 lds
    v_mad_u32_u16 v190, v190, s36, v14
    buffer_load_dwordx4 v190, s[60:63], 0 offen offset:2048 lds
    v_mad_u32_u16 v191, v191, s36, v15
    buffer_load_dwordx4 v191, s[60:63], 0 offen offset:3072 lds
    v_add_u32 v7, 128, v7
    v_add_u32 v8, 128, v8
    v_mfma_f32_32x32x16_bf16 v[180:195], v[16:19], v[244:247], v[148:163]
    s_waitcnt lgkmcnt(3)
    v_mfma_f32_32x32x16_bf16 v[180:195], v[20:23], v[228:231], v[180:195]
    s_waitcnt lgkmcnt(2)
    v_mfma_f32_32x32x16_bf16 v[180:195], v[24:27], v[232:235], v[180:195]
    s_waitcnt lgkmcnt(1)
    v_mfma_f32_32x32x16_bf16 v[180:195], v[28:31], v[236:239], v[180:195]
    s_waitcnt lgkmcnt(0)
    v_mfma_f32_32x32x16_bf16 v[180:195], v[32:35], v[240:243], v[180:195]
    s_sub_u32 s31, s31, 1
    s_cbranch_scc1 K2_DONE
    s_add_u32 m0, s35, 4096
    v_mad_u32_u16 v248, v248, s36, v1
    v_mad_u32_u16 v249, v249, s36, v2
    v_mad_u32_u16 v250, v250, s36, v14
    v_mad_u32_u16 v251, v251, s36, v15
    s_nop 7
    s_branch K2_ENTER
.p2align 6
K2_LOOP:
    v_mad_u32_u16 v248, v248, s36, v1
    v_mad_u32_u16 v249, v249, s36, v2
    v_mad_u32_u16 v250, v250, s36, v14
    v_mad_u32_u16 v251, v251, s36, v15
    v_pk_add_f32 v[132:133], v[132:133], v[196:197]
    v_pk_fma_f32 v[100:101], v[196:197], v[212:213], v[100:101]
    v_pk_add_f32 v[134:135], v[134:135], v[198:199]
    v_pk_fma_f32 v[102:103], v[198:199], v[214:215], v[102:103]
    v_pk_add_f32 v[136:137], v[136:137], v[200:201]
    v_pk_fma_f32 v[104:105], v[200:201], v[216:217], v[104:105]
    v_pk_add_f32 v[138:139], v[138:139], v[202:203]
    v_pk_fma_f32 v[106:107], v[202:203], v[218:219], v[106:107]
    v_pk_add_f32 v[140:141], v[140:141], v[204:205]
    v_pk_fma_f32 v[108:109], v[204:205], v[220:221], v[108:109]
    v_pk_add_f32 v[142:143], v[142:143], v[206:207]
    v_pk_fma_f32 v[110:111], v[206:207], v[222:223], v[110:111]
    v_pk_add_f32 v[144:145], v[144:145], v[208:209]
    v_pk_fma_f32 v[112:113], v[208:209], v[224:225], v[112:113]
    v_pk_add_f32 v[146:147], v[146:147], v[210:211]
    v_pk_fma_f32 v[114:115], v[210:211], v[226:227], v[114:115]
K2_ENTER:
    v_exp_f32_e64 v180, v180
    v_mfma_f32_32x32x16_bf16 v[212:227], v[52:55], v[228:231], 0
    v_exp_f32 v181, v181
    v_exp_f32 v182, v182
    v_exp_f32_e64 v183, v183
    v_mfma_f32_32x32x16_bf16 v[212:227], v[56:59], v[232:235], v[212:227]
    v_exp_f32 v184, v184
    v_exp_f32 v185, v185
    v_exp_f32_e64 v186, v186
    v_mfma_f32_32x32x16_bf16 v[212:227], v[60:63], v[236:239], v[212:227]
    v_exp_f32 v187, v187
    v_exp_f32 v188, v188
    v_exp_f32_e64 v189, v189
    v_mfma_f32_32x32x16_bf16 v[212:227], v[64:67], v[240:243], v[212:227]
    v_exp_f32 v190, v190
    v_exp_f32 v191, v191
    v_exp_f32 v192, v192
    v_exp_f32 v193, v193
    v_exp_f32 v194, v194
    v_exp_f32 v195, v195
    buffer_load_dwordx4 v248, s[60:63], 0 offen offset:0 lds
    buffer_load_dwordx4 v249, s[60:63], 0 offen offset:1024 lds
    buffer_load_dwordx4 v250, s[60:63], 0 offen offset:2048 lds
    buffer_load_dwordx4 v251, s[60:63], 0 offen offset:3072 lds
    ds_read_b128 v[248:251], v7 offset:8704
    ds_read_b32 v252, v8 offset:8320
    v_pk_add_f32 v[180:181], v[180:181], 1.0 op_sel_hi:[1,0]
    v_pk_add_f32 v[182:183], v[182:183], 1.0 op_sel_hi:[1,0]
    v_pk_add_f32 v[184:185], v[184:185], 1.0 op_sel_hi:[1,0]
    v_pk_add_f32 v[186:187], v[186:187], 1.0 op_sel_hi:[1,0]
    v_pk_add_f32 v[188:189], v[188:189], 1.0 op_sel_hi:[1,0]
    v_pk_add_f32 v[190:191], v[190:191], 1.0 op_sel_hi:[1,0]
    v_pk_add_f32 v[192:193], v[192:193], 1.0 op_sel_hi:[1,0]
    v_pk_add_f32 v[194:195], v[194:195], 1.0 op_sel_hi:[1,0]
    v_mfma_f32_32x32x16_bf16 v[196:211], v[18:21], v[244:247], v[164:179]
    v_rcp_f32 v180, v180
    v_rcp_f32 v181, v181
    v_rcp_f32_e64 v182, v182
    v_mfma_f32_32x32x16_bf16 v[196:211], v[36:39], v[228:231], v[196:211]
    v_rcp_f32 v183, v183
    v_rcp_f32 v184, v184
    v_rcp_f32_e64 v185, v185
    v_mfma_f32_32x32x16_bf16 v[196:211], v[40:43], v[232:235], v[196:211]
    v_rcp_f32 v186, v186
    v_rcp_f32 v187, v187
    v_rcp_f32_e64 v188, v188
    v_mfma_f32_32x32x16_bf16 v[196:211], v[44:47], v[236:239], v[196:211]
    v_rcp_f32 v189, v189
    v_rcp_f32 v190, v190
    v_rcp_f32_e64 v191, v191
    v_mfma_f32_32x32x16_bf16 v[196:211], v[48:51], v[240:243], v[196:211]
    s_waitcnt vmcnt(8) lgkmcnt(0)
    v_rcp_f32 v192, v192
    v_rcp_f32 v193, v193
    v_rcp_f32 v194, v194
    v_rcp_f32_e64 v195, v195
    v_pk_sub_u16 v244, v252, s37 clamp
    v_pk_add_f32 v[116:117], v[116:117], v[180:181]
    v_pk_fma_f32 v[84:85], v[180:181], v[212:213], v[84:85]
    v_pk_add_f32 v[118:119], v[118:119], v[182:183]
    v_pk_fma_f32 v[86:87], v[182:183], v[214:215], v[86:87]
    v_pk_add_f32 v[120:121], v[120:121], v[184:185]
    v_pk_fma_f32 v[88:89], v[184:185], v[216:217], v[88:89]
    v_pk_add_f32 v[122:123], v[122:123], v[186:187]
    v_pk_fma_f32 v[90:91], v[186:187], v[218:219], v[90:91]
    v_pk_add_f32 v[124:125], v[124:125], v[188:189]
    v_pk_fma_f32 v[92:93], v[188:189], v[220:221], v[92:93]
    v_pk_add_f32 v[126:127], v[126:127], v[190:191]
    v_pk_fma_f32 v[94:95], v[190:191], v[222:223], v[94:95]
    v_pk_add_f32 v[128:129], v[128:129], v[192:193]
    v_pk_fma_f32 v[96:97], v[192:193], v[224:225], v[96:97]
    v_pk_add_f32 v[130:131], v[130:131], v[194:195]
    v_pk_fma_f32 v[98:99], v[194:195], v[226:227], v[98:99]
    v_exp_f32_e64 v196, v196
    v_mfma_f32_32x32x16_bf16 v[212:227], v[68:71], v[228:231], 0
    ds_read_b128 v[228:231], v3 offset:8192
    v_exp_f32 v197, v197
    v_exp_f32 v198, v198
    v_exp_f32_e64 v199, v199
    v_mfma_f32_32x32x16_bf16 v[212:227], v[72:75], v[232:235], v[212:227]
    ds_read_b128 v[232:235], v4 offset:8192
    v_exp_f32 v200, v200
    v_exp_f32 v201, v201
    v_exp_f32_e64 v202, v202
    v_mfma_f32_32x32x16_bf16 v[212:227], v[76:79], v[236:239], v[212:227]
    ds_read_b128 v[236:239], v5 offset:8192
    v_exp_f32 v203, v203
    v_exp_f32 v204, v204
    v_exp_f32_e64 v205, v205
    v_mfma_f32_32x32x16_bf16 v[212:227], v[80:83], v[240:243], v[212:227]
    ds_read_b128 v[240:243], v6 offset:8192
    v_exp_f32 v206, v206
    v_exp_f32 v207, v207
    v_exp_f32 v208, v208
    v_exp_f32 v209, v209
    v_exp_f32 v210, v210
    v_exp_f32 v211, v211
    v_pk_add_f32 v[196:197], v[196:197], 1.0 op_sel_hi:[1,0]
    v_pk_add_f32 v[198:199], v[198:199], 1.0 op_sel_hi:[1,0]
    v_pk_add_f32 v[200:201], v[200:201], 1.0 op_sel_hi:[1,0]
    v_pk_add_f32 v[202:203], v[202:203], 1.0 op_sel_hi:[1,0]
    v_pk_add_f32 v[204:205], v[204:205], 1.0 op_sel_hi:[1,0]
    v_pk_add_f32 v[206:207], v[206:207], 1.0 op_sel_hi:[1,0]
    v_pk_add_f32 v[208:209], v[208:209], 1.0 op_sel_hi:[1,0]
    v_pk_add_f32 v[210:211], v[210:211], 1.0 op_sel_hi:[1,0]
    v_mfma_f32_32x32x16_bf16 v[180:195], v[16:19], v[244:247], v[148:163]
    s_waitcnt lgkmcnt(2)
    v_rcp_f32 v196, v196
    v_rcp_f32 v197, v197
    v_rcp_f32 v198, v198
    v_mfma_f32_32x32x16_bf16 v[180:195], v[20:23], v[228:231], v[180:195]
    v_rcp_f32 v199, v199
    v_rcp_f32 v200, v200
    v_rcp_f32_e64 v201, v201
    v_mfma_f32_32x32x16_bf16 v[180:195], v[24:27], v[232:235], v[180:195]
    s_waitcnt lgkmcnt(0)
    v_rcp_f32 v202, v202
    v_rcp_f32 v203, v203
    v_rcp_f32 v204, v204
    v_mfma_f32_32x32x16_bf16 v[180:195], v[28:31], v[236:239], v[180:195]
    s_add_u32 m0, s35, 8192
    v_rcp_f32 v205, v205
    v_rcp_f32 v206, v206
    v_rcp_f32_e64 v207, v207
    v_mfma_f32_32x32x16_bf16 v[180:195], v[32:35], v[240:243], v[180:195]
    s_sub_u32 s31, s31, 1
    v_rcp_f32 v208, v208
    v_rcp_f32 v209, v209
    v_rcp_f32 v210, v210
    v_rcp_f32 v211, v211
    s_cbranch_scc1 K2_EXIT
    v_mad_u32_u16 v248, v248, s36, v1
    v_mad_u32_u16 v249, v249, s36, v2
    v_mad_u32_u16 v250, v250, s36, v14
    v_mad_u32_u16 v251, v251, s36, v15
    v_pk_add_f32 v[132:133], v[132:133], v[196:197]
    v_pk_fma_f32 v[100:101], v[196:197], v[212:213], v[100:101]
    v_pk_add_f32 v[134:135], v[134:135], v[198:199]
    v_pk_fma_f32 v[102:103], v[198:199], v[214:215], v[102:103]
    v_pk_add_f32 v[136:137], v[136:137], v[200:201]
    v_pk_fma_f32 v[104:105], v[200:201], v[216:217], v[104:105]
    v_pk_add_f32 v[138:139], v[138:139], v[202:203]
    v_pk_fma_f32 v[106:107], v[202:203], v[218:219], v[106:107]
    v_pk_add_f32 v[140:141], v[140:141], v[204:205]
    v_pk_fma_f32 v[108:109], v[204:205], v[220:221], v[108:109]
    v_pk_add_f32 v[142:143], v[142:143], v[206:207]
    v_pk_fma_f32 v[110:111], v[206:207], v[222:223], v[110:111]
    v_pk_add_f32 v[144:145], v[144:145], v[208:209]
    v_pk_fma_f32 v[112:113], v[208:209], v[224:225], v[112:113]
    v_pk_add_f32 v[146:147], v[146:147], v[210:211]
    v_pk_fma_f32 v[114:115], v[210:211], v[226:227], v[114:115]
    v_exp_f32_e64 v180, v180
    v_mfma_f32_32x32x16_bf16 v[212:227], v[52:55], v[228:231], 0
    v_exp_f32 v181, v181
    v_exp_f32 v182, v182
    v_exp_f32_e64 v183, v183
    v_mfma_f32_32x32x16_bf16 v[212:227], v[56:59], v[232:235], v[212:227]
    v_exp_f32 v184, v184
    v_exp_f32 v185, v185
    v_exp_f32_e64 v186, v186
    v_mfma_f32_32x32x16_bf16 v[212:227], v[60:63], v[236:239], v[212:227]
    v_exp_f32 v187, v187
    v_exp_f32 v188, v188
    v_exp_f32_e64 v189, v189
    v_mfma_f32_32x32x16_bf16 v[212:227], v[64:67], v[240:243], v[212:227]
    v_exp_f32 v190, v190
    v_exp_f32 v191, v191
    v_exp_f32 v192, v192
    v_exp_f32 v193, v193
    v_exp_f32 v194, v194
    v_exp_f32 v195, v195
    buffer_load_dwordx4 v248, s[60:63], 0 offen offset:0 lds
    buffer_load_dwordx4 v249, s[60:63], 0 offen offset:1024 lds
    buffer_load_dwordx4 v250, s[60:63], 0 offen offset:2048 lds
    buffer_load_dwordx4 v251, s[60:63], 0 offen offset:3072 lds
    ds_read_b128 v[248:251], v7 offset:8832
    ds_read_b32 v252, v8 offset:8448
    v_pk_add_f32 v[180:181], v[180:181], 1.0 op_sel_hi:[1,0]
    v_pk_add_f32 v[182:183], v[182:183], 1.0 op_sel_hi:[1,0]
    v_pk_add_f32 v[184:185], v[184:185], 1.0 op_sel_hi:[1,0]
    v_pk_add_f32 v[186:187], v[186:187], 1.0 op_sel_hi:[1,0]
    v_pk_add_f32 v[188:189], v[188:189], 1.0 op_sel_hi:[1,0]
    v_pk_add_f32 v[190:191], v[190:191], 1.0 op_sel_hi:[1,0]
    v_pk_add_f32 v[192:193], v[192:193], 1.0 op_sel_hi:[1,0]
    v_pk_add_f32 v[194:195], v[194:195], 1.0 op_sel_hi:[1,0]
    v_mfma_f32_32x32x16_bf16 v[196:211], v[18:21], v[244:247], v[164:179]
    v_rcp_f32 v180, v180
    v_rcp_f32 v181, v181
    v_rcp_f32_e64 v182, v182
    v_mfma_f32_32x32x16_bf16 v[196:211], v[36:39], v[228:231], v[196:211]
    v_rcp_f32 v183, v183
    v_rcp_f32 v184, v184
    v_rcp_f32_e64 v185, v185
    v_mfma_f32_32x32x16_bf16 v[196:211], v[40:43], v[232:235], v[196:211]
    v_rcp_f32 v186, v186
    v_rcp_f32 v187, v187
    v_rcp_f32_e64 v188, v188
    v_mfma_f32_32x32x16_bf16 v[196:211], v[44:47], v[236:239], v[196:211]
    v_rcp_f32 v189, v189
    v_rcp_f32 v190, v190
    v_rcp_f32_e64 v191, v191
    v_mfma_f32_32x32x16_bf16 v[196:211], v[48:51], v[240:243], v[196:211]
    s_waitcnt vmcnt(8) lgkmcnt(0)
    v_rcp_f32 v192, v192
    v_rcp_f32 v193, v193
    v_rcp_f32 v194, v194
    v_rcp_f32_e64 v195, v195
    v_pk_sub_u16 v244, v252, s37 clamp
    v_pk_add_f32 v[116:117], v[116:117], v[180:181]
    v_pk_fma_f32 v[84:85], v[180:181], v[212:213], v[84:85]
    v_pk_add_f32 v[118:119], v[118:119], v[182:183]
    v_pk_fma_f32 v[86:87], v[182:183], v[214:215], v[86:87]
    v_pk_add_f32 v[120:121], v[120:121], v[184:185]
    v_pk_fma_f32 v[88:89], v[184:185], v[216:217], v[88:89]
    v_pk_add_f32 v[122:123], v[122:123], v[186:187]
    v_pk_fma_f32 v[90:91], v[186:187], v[218:219], v[90:91]
    v_pk_add_f32 v[124:125], v[124:125], v[188:189]
    v_pk_fma_f32 v[92:93], v[188:189], v[220:221], v[92:93]
    v_pk_add_f32 v[126:127], v[126:127], v[190:191]
    v_pk_fma_f32 v[94:95], v[190:191], v[222:223], v[94:95]
    v_pk_add_f32 v[128:129], v[128:129], v[192:193]
    v_pk_fma_f32 v[96:97], v[192:193], v[224:225], v[96:97]
    v_pk_add_f32 v[130:131], v[130:131], v[194:195]
    v_pk_fma_f32 v[98:99], v[194:195], v[226:227], v[98:99]
    v_exp_f32_e64 v196, v196
    v_mfma_f32_32x32x16_bf16 v[212:227], v[68:71], v[228:231], 0
    ds_read_b128 v[228:231], v3 offset:0
    v_exp_f32 v197, v197
    v_exp_f32 v198, v198
    v_exp_f32_e64 v199, v199
    v_mfma_f32_32x32x16_bf16 v[212:227], v[72:75], v[232:235], v[212:227]
    ds_read_b128 v[232:235], v4 offset:0
    v_exp_f32 v200, v200
    v_exp_f32 v201, v201
    v_exp_f32_e64 v202, v202
    v_mfma_f32_32x32x16_bf16 v[212:227], v[76:79], v[236:239], v[212:227]
    ds_read_b128 v[236:239], v5 offset:0
    v_exp_f32 v203, v203
    v_exp_f32 v204, v204
    v_exp_f32_e64 v205, v205
    v_mfma_f32_32x32x16_bf16 v[212:227], v[80:83], v[240:243], v[212:227]
    ds_read_b128 v[240:243], v6 offset:0
    v_exp_f32 v206, v206
    v_exp_f32 v207, v207
    v_exp_f32 v208, v208
    v_exp_f32 v209, v209
    v_exp_f32 v210, v210
    v_exp_f32 v211, v211
    v_pk_add_f32 v[196:197], v[196:197], 1.0 op_sel_hi:[1,0]
    v_pk_add_f32 v[198:199], v[198:199], 1.0 op_sel_hi:[1,0]
    v_pk_add_f32 v[200:201], v[200:201], 1.0 op_sel_hi:[1,0]
    v_pk_add_f32 v[202:203], v[202:203], 1.0 op_sel_hi:[1,0]
    v_pk_add_f32 v[204:205], v[204:205], 1.0 op_sel_hi:[1,0]
    v_pk_add_f32 v[206:207], v[206:207], 1.0 op_sel_hi:[1,0]
    v_pk_add_f32 v[208:209], v[208:209], 1.0 op_sel_hi:[1,0]
    v_pk_add_f32 v[210:211], v[210:211], 1.0 op_sel_hi:[1,0]
    v_mfma_f32_32x32x16_bf16 v[180:195], v[16:19], v[244:247], v[148:163]
    s_waitcnt lgkmcnt(2)
    v_rcp_f32 v196, v196
    v_rcp_f32 v197, v197
    v_rcp_f32 v198, v198
    v_mfma_f32_32x32x16_bf16 v[180:195], v[20:23], v[228:231], v[180:195]
    v_rcp_f32 v199, v199
    v_rcp_f32 v200, v200
    v_rcp_f32_e64 v201, v201
    v_mfma_f32_32x32x16_bf16 v[180:195], v[24:27], v[232:235], v[180:195]
    s_waitcnt lgkmcnt(0)
    v_rcp_f32 v202, v202
    v_rcp_f32 v203, v203
    v_rcp_f32 v204, v204
    v_mfma_f32_32x32x16_bf16 v[180:195], v[28:31], v[236:239], v[180:195]
    s_add_u32 m0, s35, 0
    v_rcp_f32 v205, v205
    v_rcp_f32 v206, v206
    v_rcp_f32 v207, v207
    v_mfma_f32_32x32x16_bf16 v[180:195], v[32:35], v[240:243], v[180:195]
    s_sub_u32 s31, s31, 1
    v_rcp_f32 v208, v208
    v_rcp_f32 v209, v209
    v_rcp_f32 v210, v210
    v_rcp_f32 v211, v211
    s_cbranch_scc1 K2_EXIT
    v_mad_u32_u16 v248, v248, s36, v1
    v_mad_u32_u16 v249, v249, s36, v2
    v_mad_u32_u16 v250, v250, s36, v14
    v_mad_u32_u16 v251, v251, s36, v15
    v_pk_add_f32 v[132:133], v[132:133], v[196:197]
    v_pk_fma_f32 v[100:101], v[196:197], v[212:213], v[100:101]
    v_pk_add_f32 v[134:135], v[134:135], v[198:199]
    v_pk_fma_f32 v[102:103], v[198:199], v[214:215], v[102:103]
    v_pk_add_f32 v[136:137], v[136:137], v[200:201]
    v_pk_fma_f32 v[104:105], v[200:201], v[216:217], v[104:105]
    v_pk_add_f32 v[138:139], v[138:139], v[202:203]
    v_pk_fma_f32 v[106:107], v[202:203], v[218:219], v[106:107]
    v_pk_add_f32 v[140:141], v[140:141], v[204:205]
    v_pk_fma_f32 v[108:109], v[204:205], v[220:221], v[108:109]
    v_pk_add_f32 v[142:143], v[142:143], v[206:207]
    v_pk_fma_f32 v[110:111], v[206:207], v[222:223], v[110:111]
    v_pk_add_f32 v[144:145], v[144:145], v[208:209]
    v_pk_fma_f32 v[112:113], v[208:209], v[224:225], v[112:113]
    v_pk_add_f32 v[146:147], v[146:147], v[210:211]
    v_pk_fma_f32 v[114:115], v[210:211], v[226:227], v[114:115]
    v_exp_f32_e64 v180, v180
    v_mfma_f32_32x32x16_bf16 v[212:227], v[52:55], v[228:231], 0
    v_exp_f32 v181, v181
    v_exp_f32 v182, v182
    v_exp_f32_e64 v183, v183
    v_mfma_f32_32x32x16_bf16 v[212:227], v[56:59], v[232:235], v[212:227]
    v_exp_f32 v184, v184
    v_exp_f32 v185, v185
    v_exp_f32_e64 v186, v186
    v_mfma_f32_32x32x16_bf16 v[212:227], v[60:63], v[236:239], v[212:227]
    v_exp_f32 v187, v187
    v_exp_f32 v188, v188
    v_exp_f32_e64 v189, v189
    v_mfma_f32_32x32x16_bf16 v[212:227], v[64:67], v[240:243], v[212:227]
    v_exp_f32 v190, v190
    v_exp_f32 v191, v191
    v_exp_f32 v192, v192
    v_exp_f32 v193, v193
    v_exp_f32 v194, v194
    v_exp_f32 v195, v195
    buffer_load_dwordx4 v248, s[60:63], 0 offen offset:0 lds
    buffer_load_dwordx4 v249, s[60:63], 0 offen offset:1024 lds
    buffer_load_dwordx4 v250, s[60:63], 0 offen offset:2048 lds
    buffer_load_dwordx4 v251, s[60:63], 0 offen offset:3072 lds
    ds_read_b128 v[248:251], v7 offset:8960
    ds_read_b32 v252, v8 offset:8576
    v_pk_add_f32 v[180:181], v[180:181], 1.0 op_sel_hi:[1,0]
    v_pk_add_f32 v[182:183], v[182:183], 1.0 op_sel_hi:[1,0]
    v_pk_add_f32 v[184:185], v[184:185], 1.0 op_sel_hi:[1,0]
    v_pk_add_f32 v[186:187], v[186:187], 1.0 op_sel_hi:[1,0]
    v_pk_add_f32 v[188:189], v[188:189], 1.0 op_sel_hi:[1,0]
    v_pk_add_f32 v[190:191], v[190:191], 1.0 op_sel_hi:[1,0]
    v_pk_add_f32 v[192:193], v[192:193], 1.0 op_sel_hi:[1,0]
    v_pk_add_f32 v[194:195], v[194:195], 1.0 op_sel_hi:[1,0]
    v_mfma_f32_32x32x16_bf16 v[196:211], v[18:21], v[244:247], v[164:179]
    v_rcp_f32 v180, v180
    v_rcp_f32 v181, v181
    v_rcp_f32_e64 v182, v182
    v_mfma_f32_32x32x16_bf16 v[196:211], v[36:39], v[228:231], v[196:211]
    v_rcp_f32 v183, v183
    v_rcp_f32 v184, v184
    v_rcp_f32_e64 v185, v185
    v_mfma_f32_32x32x16_bf16 v[196:211], v[40:43], v[232:235], v[196:211]
    v_rcp_f32 v186, v186
    v_rcp_f32 v187, v187
    v_rcp_f32_e64 v188, v188
    v_mfma_f32_32x32x16_bf16 v[196:211], v[44:47], v[236:239], v[196:211]
    v_rcp_f32 v189, v189
    v_rcp_f32 v190, v190
    v_rcp_f32_e64 v191, v191
    v_mfma_f32_32x32x16_bf16 v[196:211], v[48:51], v[240:243], v[196:211]
    s_waitcnt vmcnt(8) lgkmcnt(0)
    v_rcp_f32 v192, v192
    v_rcp_f32 v193, v193
    v_rcp_f32 v194, v194
    v_rcp_f32_e64 v195, v195
    v_pk_sub_u16 v244, v252, s37 clamp
    v_pk_add_f32 v[116:117], v[116:117], v[180:181]
    v_pk_fma_f32 v[84:85], v[180:181], v[212:213], v[84:85]
    v_pk_add_f32 v[118:119], v[118:119], v[182:183]
    v_pk_fma_f32 v[86:87], v[182:183], v[214:215], v[86:87]
    v_pk_add_f32 v[120:121], v[120:121], v[184:185]
    v_pk_fma_f32 v[88:89], v[184:185], v[216:217], v[88:89]
    v_pk_add_f32 v[122:123], v[122:123], v[186:187]
    v_pk_fma_f32 v[90:91], v[186:187], v[218:219], v[90:91]
    v_pk_add_f32 v[124:125], v[124:125], v[188:189]
    v_pk_fma_f32 v[92:93], v[188:189], v[220:221], v[92:93]
    v_pk_add_f32 v[126:127], v[126:127], v[190:191]
    v_pk_fma_f32 v[94:95], v[190:191], v[222:223], v[94:95]
    v_pk_add_f32 v[128:129], v[128:129], v[192:193]
    v_pk_fma_f32 v[96:97], v[192:193], v[224:225], v[96:97]
    v_pk_add_f32 v[130:131], v[130:131], v[194:195]
    v_pk_fma_f32 v[98:99], v[194:195], v[226:227], v[98:99]
    v_exp_f32_e64 v196, v196
    v_mfma_f32_32x32x16_bf16 v[212:227], v[68:71], v[228:231], 0
    ds_read_b128 v[228:231], v3 offset:4096
    v_exp_f32 v197, v197
    v_exp_f32 v198, v198
    v_exp_f32_e64 v199, v199
    v_mfma_f32_32x32x16_bf16 v[212:227], v[72:75], v[232:235], v[212:227]
    ds_read_b128 v[232:235], v4 offset:4096
    v_exp_f32 v200, v200
    v_exp_f32 v201, v201
    v_exp_f32_e64 v202, v202
    v_mfma_f32_32x32x16_bf16 v[212:227], v[76:79], v[236:239], v[212:227]
    ds_read_b128 v[236:239], v5 offset:4096
    v_exp_f32 v203, v203
    v_exp_f32 v204, v204
    v_exp_f32_e64 v205, v205
    v_mfma_f32_32x32x16_bf16 v[212:227], v[80:83], v[240:243], v[212:227]
    ds_read_b128 v[240:243], v6 offset:4096
    v_exp_f32 v206, v206
    v_exp_f32 v207, v207
    v_exp_f32 v208, v208
    v_exp_f32 v209, v209
    v_exp_f32 v210, v210
    v_exp_f32 v211, v211
    v_add_u32 v7, 384, v7
    v_add_u32 v8, 384, v8
    v_pk_add_f32 v[196:197], v[196:197], 1.0 op_sel_hi:[1,0]
    v_pk_add_f32 v[198:199], v[198:199], 1.0 op_sel_hi:[1,0]
    v_pk_add_f32 v[200:201], v[200:201], 1.0 op_sel_hi:[1,0]
    v_pk_add_f32 v[202:203], v[202:203], 1.0 op_sel_hi:[1,0]
    v_pk_add_f32 v[204:205], v[204:205], 1.0 op_sel_hi:[1,0]
    v_pk_add_f32 v[206:207], v[206:207], 1.0 op_sel_hi:[1,0]
    v_pk_add_f32 v[208:209], v[208:209], 1.0 op_sel_hi:[1,0]
    v_pk_add_f32 v[210:211], v[210:211], 1.0 op_sel_hi:[1,0]
    v_mfma_f32_32x32x16_bf16 v[180:195], v[16:19], v[244:247], v[148:163]
    s_waitcnt lgkmcnt(2)
    v_rcp_f32 v196, v196
    v_rcp_f32 v197, v197
    v_rcp_f32 v198, v198
    v_mfma_f32_32x32x16_bf16 v[180:195], v[20:23], v[228:231], v[180:195]
    v_rcp_f32 v199, v199
    v_rcp_f32 v200, v200
    v_rcp_f32_e64 v201, v201
    v_mfma_f32_32x32x16_bf16 v[180:195], v[24:27], v[232:235], v[180:195]
    s_waitcnt lgkmcnt(0)
    v_rcp_f32 v202, v202
    v_rcp_f32 v203, v203
    v_rcp_f32 v204, v204
    v_mfma_f32_32x32x16_bf16 v[180:195], v[28:31], v[236:239], v[180:195]
    s_add_u32 m0, s35, 4096
    v_rcp_f32 v205, v205
    v_rcp_f32 v206, v206
    v_rcp_f32_e64 v207, v207
    v_mfma_f32_32x32x16_bf16 v[180:195], v[32:35], v[240:243], v[180:195]
    s_sub_u32 s31, s31, 1
    v_rcp_f32 v208, v208
    v_rcp_f32 v209, v209
    v_rcp_f32 v210, v210
    v_rcp_f32 v211, v211
    s_cbranch_scc0 K2_LOOP
K2_EXIT:
    v_pk_add_f32 v[132:133], v[132:133], v[196:197]
    v_pk_fma_f32 v[100:101], v[196:197], v[212:213], v[100:101]
    v_pk_add_f32 v[134:135], v[134:135], v[198:199]
    v_pk_fma_f32 v[102:103], v[198:199], v[214:215], v[102:103]
    v_pk_add_f32 v[136:137], v[136:137], v[200:201]
    v_pk_fma_f32 v[104:105], v[200:201], v[216:217], v[104:105]
    v_pk_add_f32 v[138:139], v[138:139], v[202:203]
    v_pk_fma_f32 v[106:107], v[202:203], v[218:219], v[106:107]
    v_pk_add_f32 v[140:141], v[140:141], v[204:205]
    v_pk_fma_f32 v[108:109], v[204:205], v[220:221], v[108:109]
    v_pk_add_f32 v[142:143], v[142:143], v[206:207]
    v_pk_fma_f32 v[110:111], v[206:207], v[222:223], v[110:111]
    v_pk_add_f32 v[144:145], v[144:145], v[208:209]
    v_pk_fma_f32 v[112:113], v[208:209], v[224:225], v[112:113]
    v_pk_add_f32 v[146:147], v[146:147], v[210:211]
    v_pk_fma_f32 v[114:115], v[210:211], v[226:227], v[114:115]
K2_DONE:
    s_cmp_lg_u32 s38, 0
    s_cbranch_scc1 K2_SLOW_NEXT
K2_EPI:
    v_lshlrev_b32 v18, 4, v9
    s_mov_b32 vcc_lo, 0xffff0000
    s_mov_b32 vcc_hi, 0xffff0000
    v_cndmask_b32 v16, v18, 64, vcc
    v_cndmask_b32 v17, 64, v18, vcc
    ds_read_b128 v[52:55], v16 offset:3072
    ds_read_b128 v[56:59], v17 offset:3072
    ds_read_b128 v[20:23], v18 offset:57344
    ds_read_b128 v[24:27], v18 offset:58368
    ds_read_b128 v[28:31], v18 offset:59392
    ds_read_b128 v[32:35], v18 offset:60416
    ds_read_b128 v[36:39], v18 offset:61440
    ds_read_b128 v[40:43], v18 offset:62464
    ds_read_b128 v[44:47], v18 offset:63488
    ds_read_b128 v[48:51], v18 offset:64512
    v_add_u32 v18, s35, v18
    s_cmp_eq_u32 s39, 0
    s_cbranch_scc1 K2_NOCOMB
    s_mov_b64 exec, s[54:55]
    s_nop 0
    v_add_f32_dpp v84, v84, v84 quad_perm:[1,0,3,2] row_mask:0xf bank_mask:0xf
    v_add_f32_dpp v85, v85, v85 quad_perm:[1,0,3,2] row_mask:0xf bank_mask:0xf
    v_add_f32_dpp v86, v86, v86 quad_perm:[1,0,3,2] row_mask:0xf bank_mask:0xf
    v_add_f32_dpp v87, v87, v87 quad_perm:[1,0,3,2] row_mask:0xf bank_mask:0xf
    v_add_f32_dpp v88, v88, v88 quad_perm:[1,0,3,2] row_mask:0xf bank_mask:0xf
    v_add_f32_dpp v89, v89, v89 quad_perm:[1,0,3,2] row_mask:0xf bank_mask:0xf
    v_add_f32_dpp v90, v90, v90 quad_perm:[1,0,3,2] row_mask:0xf bank_mask:0xf
    v_add_f32_dpp v91, v91, v91 quad_perm:[1,0,3,2] row_mask:0xf bank_mask:0xf
    v_add_f32_dpp v92, v92, v92 quad_perm:[1,0,3,2] row_mask:0xf bank_mask:0xf
    v_add_f32_dpp v93, v93, v93 quad_perm:[1,0,3,2] row_mask:0xf bank_mask:0xf
    v_add_f32_dpp v94, v94, v94 quad_perm:[1,0,3,2] row_mask:0xf bank_mask:0xf
    v_add_f32_dpp v95, v95, v95 quad_perm:[1,0,3,2] row_mask:0xf bank_mask:0xf
    v_add_f32_dpp v96, v96, v96 quad_perm:[1,0,3,2] row_mask:0xf bank_mask:0xf
    v_add_f32_dpp v97, v97, v97 quad_perm:[1,0,3,2] row_mask:0xf bank_mask:0xf
    v_add_f32_dpp v98, v98, v98 quad_perm:[1,0,3,2] row_mask:0xf bank_mask:0xf
    v_add_f32_dpp v99, v99, v99 quad_perm:[1,0,3,2] row_mask:0xf bank_mask:0xf
    v_add_f32_dpp v100, v100, v100 quad_perm:[1,0,3,2] row_mask:0xf bank_mask:0xf
    v_add_f32_dpp v101, v101, v101 quad_perm:[1,0,3,2] row_mask:0xf bank_mask:0xf
    v_add_f32_dpp v102, v102, v102 quad_perm:[1,0,3,2] row_mask:0xf bank_mask:0xf
    v_add_f32_dpp v103, v103, v103 quad_perm:[1,0,3,2] row_mask:0xf bank_mask:0xf
    v_add_f32_dpp v104, v104, v104 quad_perm:[1,0,3,2] row_mask:0xf bank_mask:0xf
    v_add_f32_dpp v105, v105, v105 quad_perm:[1,0,3,2] row_mask:0xf bank_mask:0xf
    v_add_f32_dpp v106, v106, v106 quad_perm:[1,0,3,2] row_mask:0xf bank_mask:0xf
    v_add_f32_dpp v107, v107, v107 quad_perm:[1,0,3,2] row_mask:0xf bank_mask:0xf
    v_add_f32_dpp v108, v108, v108 quad_perm:[1,0,3,2] row_mask:0xf bank_mask:0xf
    v_add_f32_dpp v109, v109, v109 quad_perm:[1,0,3,2] row_mask:0xf bank_mask:0xf
    v_add_f32_dpp v110, v110, v110 quad_perm:[1,0,3,2] row_mask:0xf bank_mask:0xf
    v_add_f32_dpp v111, v111, v111 quad_perm:[1,0,3,2] row_mask:0xf bank_mask:0xf
    v_add_f32_dpp v112, v112, v112 quad_perm:[1,0,3,2] row_mask:0xf bank_mask:0xf
    v_add_f32_dpp v113, v113, v113 quad_perm:[1,0,3,2] row_mask:0xf bank_mask:0xf
    v_add_f32_dpp v114, v114, v114 quad_perm:[1,0,3,2] row_mask:0xf bank_mask:0xf
    v_add_f32_dpp v115, v115, v115 quad_perm:[1,0,3,2] row_mask:0xf bank_mask:0xf
    v_add_f32_dpp v116, v116, v116 quad_perm:[1,0,3,2] row_mask:0xf bank_mask:0xf
    v_add_f32_dpp v117, v117, v117 quad_perm:[1,0,3,2] row_mask:0xf bank_mask:0xf
    v_add_f32_dpp v118, v118, v118 quad_perm:[1,0,3,2] row_mask:0xf bank_mask:0xf
    v_add_f32_dpp v119, v119, v119 quad_perm:[1,0,3,2] row_mask:0xf bank_mask:0xf
    v_add_f32_dpp v120, v120, v120 quad_perm:[1,0,3,2] row_mask:0xf bank_mask:0xf
    v_add_f32_dpp v121, v121, v121 quad_perm:[1,0,3,2] row_mask:0xf bank_mask:0xf
    v_add_f32_dpp v122, v122, v122 quad_perm:[1,0,3,2] row_mask:0xf bank_mask:0xf
    v_add_f32_dpp v123, v123, v123 quad_perm:[1,0,3,2] row_mask:0xf bank_mask:0xf
    v_add_f32_dpp v124, v124, v124 quad_perm:[1,0,3,2] row_mask:0xf bank_mask:0xf
    v_add_f32_dpp v125, v125, v125 quad_perm:[1,0,3,2] row_mask:0xf bank_mask:0xf
    v_add_f32_dpp v126, v126, v126 quad_perm:[1,0,3,2] row_mask:0xf bank_mask:0xf
    v_add_f32_dpp v127, v127, v127 quad_perm:[1,0,3,2] row_mask:0xf bank_mask:0xf
    v_add_f32_dpp v128, v128, v128 quad_perm:[1,0,3,2] row_mask:0xf bank_mask:0xf
    v_add_f32_dpp v129, v129, v129 quad_perm:[1,0,3,2] row_mask:0xf bank_mask:0xf
    v_add_f32_dpp v130, v130, v130 quad_perm:[1,0,3,2] row_mask:0xf bank_mask:0xf
    v_add_f32_dpp v131, v131, v131 quad_perm:[1,0,3,2] row_mask:0xf bank_mask:0xf
    v_add_f32_dpp v132, v132, v132 quad_perm:[1,0,3,2] row_mask:0xf bank_mask:0xf
    v_add_f32_dpp v133, v133, v133 quad_perm:[1,0,3,2] row_mask:0xf bank_mask:0xf
    v_add_f32_dpp v134, v134, v134 quad_perm:[1,0,3,2] row_mask:0xf bank_mask:0xf
    v_add_f32_dpp v135, v135, v135 quad_perm:[1,0,3,2] row_mask:0xf bank_mask:0xf
    v_add_f32_dpp v136, v136, v136 quad_perm:[1,0,3,2] row_mask:0xf bank_mask:0xf
    v_add_f32_dpp v137, v137, v137 quad_perm:[1,0,3,2] row_mask:0xf bank_mask:0xf
    v_add_f32_dpp v138, v138, v138 quad_perm:[1,0,3,2] row_mask:0xf bank_mask:0xf
    v_add_f32_dpp v139, v139, v139 quad_perm:[1,0,3,2] row_mask:0xf bank_mask:0xf
    v_add_f32_dpp v140, v140, v140 quad_perm:[1,0,3,2] row_mask:0xf bank_mask:0xf
    v_add_f32_dpp v141, v141, v141 quad_perm:[1,0,3,2] row_mask:0xf bank_mask:0xf
    v_add_f32_dpp v142, v142, v142 quad_perm:[1,0,3,2] row_mask:0xf bank_mask:0xf
    v_add_f32_dpp v143, v143, v143 quad_perm:[1,0,3,2] row_mask:0xf bank_mask:0xf
    v_add_f32_dpp v144, v144, v144 quad_perm:[1,0,3,2] row_mask:0xf bank_mask:0xf
    v_add_f32_dpp v145, v145, v145 quad_perm:[1,0,3,2] row_mask:0xf bank_mask:0xf
    v_add_f32_dpp v146, v146, v146 quad_perm:[1,0,3,2] row_mask:0xf bank_mask:0xf
    v_add_f32_dpp v147, v147, v147 quad_perm:[1,0,3,2] row_mask:0xf bank_mask:0xf
    s_mov_b64 exec, -1
    s_cmp_eq_u32 s39, 1
    s_cbranch_scc1 K2_NOCOMB
    v_add_f32_dpp v84, v84, v84 quad_perm:[2,3,0,1] row_mask:0xf bank_mask:0xf
    v_add_f32_dpp v85, v85, v85 quad_perm:[2,3,0,1] row_mask:0xf bank_mask:0xf
    v_add_f32_dpp v86, v86, v86 quad_perm:[2,3,0,1] row_mask:0xf bank_mask:0xf
    v_add_f32_dpp v87, v87, v87 quad_perm:[2,3,0,1] row_mask:0xf bank_mask:0xf
    v_add_f32_dpp v88, v88, v88 quad_perm:[2,3,0,1] row_mask:0xf bank_mask:0xf
    v_add_f32_dpp v89, v89, v89 quad_perm:[2,3,0,1] row_mask:0xf bank_mask:0xf
    v_add_f32_dpp v90, v90, v90 quad_perm:[2,3,0,1] row_mask:0xf bank_mask:0xf
    v_add_f32_dpp v91, v91, v91 quad_perm:[2,3,0,1] row_mask:0xf bank_mask:0xf
    v_add_f32_dpp v92, v92, v92 quad_perm:[2,3,0,1] row_mask:0xf bank_mask:0xf
    v_add_f32_dpp v93, v93, v93 quad_perm:[2,3,0,1] row_mask:0xf bank_mask:0xf
    v_add_f32_dpp v94, v94, v94 quad_perm:[2,3,0,1] row_mask:0xf bank_mask:0xf
    v_add_f32_dpp v95, v95, v95 quad_perm:[2,3,0,1] row_mask:0xf bank_mask:0xf
    v_add_f32_dpp v96, v96, v96 quad_perm:[2,3,0,1] row_mask:0xf bank_mask:0xf
    v_add_f32_dpp v97, v97, v97 quad_perm:[2,3,0,1] row_mask:0xf bank_mask:0xf
    v_add_f32_dpp v98, v98, v98 quad_perm:[2,3,0,1] row_mask:0xf bank_mask:0xf
    v_add_f32_dpp v99, v99, v99 quad_perm:[2,3,0,1] row_mask:0xf bank_mask:0xf
    v_add_f32_dpp v100, v100, v100 quad_perm:[2,3,0,1] row_mask:0xf bank_mask:0xf
    v_add_f32_dpp v101, v101, v101 quad_perm:[2,3,0,1] row_mask:0xf bank_mask:0xf
    v_add_f32_dpp v102, v102, v102 quad_perm:[2,3,0,1] row_mask:0xf bank_mask:0xf
    v_add_f32_dpp v103, v103, v103 quad_perm:[2,3,0,1] row_mask:0xf bank_mask:0xf
    v_add_f32_dpp v104, v104, v104 quad_perm:[2,3,0,1] row_mask:0xf bank_mask:0xf
    v_add_f32_dpp v105, v105, v105 quad_perm:[2,3,0,1] row_mask:0xf bank_mask:0xf
    v_add_f32_dpp v106, v106, v106 quad_perm:[2,3,0,1] row_mask:0xf bank_mask:0xf
    v_add_f32_dpp v107, v107, v107 quad_perm:[2,3,0,1] row_mask:0xf bank_mask:0xf
    v_add_f32_dpp v108, v108, v108 quad_perm:[2,3,0,1] row_mask:0xf bank_mask:0xf
    v_add_f32_dpp v109, v109, v109 quad_perm:[2,3,0,1] row_mask:0xf bank_mask:0xf
    v_add_f32_dpp v110, v110, v110 quad_perm:[2,3,0,1] row_mask:0xf bank_mask:0xf
    v_add_f32_dpp v111, v111, v111 quad_perm:[2,3,0,1] row_mask:0xf bank_mask:0xf
    v_add_f32_dpp v112, v112, v112 quad_perm:[2,3,0,1] row_mask:0xf bank_mask:0xf
    v_add_f32_dpp v113, v113, v113 quad_perm:[2,3,0,1] row_mask:0xf bank_mask:0xf
    v_add_f32_dpp v114, v114, v114 quad_perm:[2,3,0,1] row_mask:0xf bank_mask:0xf
    v_add_f32_dpp v115, v115, v115 quad_perm:[2,3,0,1] row_mask:0xf bank_mask:0xf
    v_add_f32_dpp v116, v116, v116 quad_perm:[2,3,0,1] row_mask:0xf bank_mask:0xf
    v_add_f32_dpp v117, v117, v117 quad_perm:[2,3,0,1] row_mask:0xf bank_mask:0xf
    v_add_f32_dpp v118, v118, v118 quad_perm:[2,3,0,1] row_mask:0xf bank_mask:0xf
    v_add_f32_dpp v119, v119, v119 quad_perm:[2,3,0,1] row_mask:0xf bank_mask:0xf
    v_add_f32_dpp v120, v120, v120 quad_perm:[2,3,0,1] row_mask:0xf bank_mask:0xf
    v_add_f32_dpp v121, v121, v121 quad_perm:[2,3,0,1] row_mask:0xf bank_mask:0xf
    v_add_f32_dpp v122, v122, v122 quad_perm:[2,3,0,1] row_mask:0xf bank_mask:0xf
    v_add_f32_dpp v123, v123, v123 quad_perm:[2,3,0,1] row_mask:0xf bank_mask:0xf
    v_add_f32_dpp v124, v124, v124 quad_perm:[2,3,0,1] row_mask:0xf bank_mask:0xf
    v_add_f32_dpp v125, v125, v125 quad_perm:[2,3,0,1] row_mask:0xf bank_mask:0xf
    v_add_f32_dpp v126, v126, v126 quad_perm:[2,3,0,1] row_mask:0xf bank_mask:0xf
    v_add_f32_dpp v127, v127, v127 quad_perm:[2,3,0,1] row_mask:0xf bank_mask:0xf
    v_add_f32_dpp v128, v128, v128 quad_perm:[2,3,0,1] row_mask:0xf bank_mask:0xf
    v_add_f32_dpp v129, v129, v129 quad_perm:[2,3,0,1] row_mask:0xf bank_mask:0xf
    v_add_f32_dpp v130, v130, v130 quad_perm:[2,3,0,1] row_mask:0xf bank_mask:0xf
    v_add_f32_dpp v131, v131, v131 quad_perm:[2,3,0,1] row_mask:0xf bank_mask:0xf
    v_add_f32_dpp v132, v132, v132 quad_perm:[2,3,0,1] row_mask:0xf bank_mask:0xf
    v_add_f32_dpp v133, v133, v133 quad_perm:[2,3,0,1] row_mask:0xf bank_mask:0xf
    v_add_f32_dpp v134, v134, v134 quad_perm:[2,3,0,1] row_mask:0xf bank_mask:0xf
    v_add_f32_dpp v135, v135, v135 quad_perm:[2,3,0,1] row_mask:0xf bank_mask:0xf
    v_add_f32_dpp v136, v136, v136 quad_perm:[2,3,0,1] row_mask:0xf bank_mask:0xf
    v_add_f32_dpp v137, v137, v137 quad_perm:[2,3,0,1] row_mask:0xf bank_mask:0xf
    v_add_f32_dpp v138, v138, v138 quad_perm:[2,3,0,1] row_mask:0xf bank_mask:0xf
    v_add_f32_dpp v139, v139, v139 quad_perm:[2,3,0,1] row_mask:0xf bank_mask:0xf
    v_add_f32_dpp v140, v140, v140 quad_perm:[2,3,0,1] row_mask:0xf bank_mask:0xf
    v_add_f32_dpp v141, v141, v141 quad_perm:[2,3,0,1] row_mask:0xf bank_mask:0xf
    v_add_f32_dpp v142, v142, v142 quad_perm:[2,3,0,1] row_mask:0xf bank_mask:0xf
    v_add_f32_dpp v143, v143, v143 quad_perm:[2,3,0,1] row_mask:0xf bank_mask:0xf
    v_add_f32_dpp v144, v144, v144 quad_perm:[2,3,0,1] row_mask:0xf bank_mask:0xf
    v_add_f32_dpp v145, v145, v145 quad_perm:[2,3,0,1] row_mask:0xf bank_mask:0xf
    v_add_f32_dpp v146, v146, v146 quad_perm:[2,3,0,1] row_mask:0xf bank_mask:0xf
    v_add_f32_dpp v147, v147, v147 quad_perm:[2,3,0,1] row_mask:0xf bank_mask:0xf
K2_NOCOMB:
    v_rcp_f32 v116, v116
    v_rcp_f32 v117, v117
    s_waitcnt lgkmcnt(8)
    v_mfma_f32_32x32x16_bf16 v[148:163], v[52:55], v[228:231], 0
    v_rcp_f32 v118, v118
    v_mfma_f32_32x32x16_bf16 v[148:163], v[56:59], v[232:235], v[148:163]
    v_rcp_f32 v119, v119
    v_rcp_f32 v120, v120
    v_rcp_f32 v121, v121
    v_mfma_f32_32x32x16_bf16 v[164:179], v[52:55], v[236:239], 0
    v_rcp_f32 v122, v122
    v_rcp_f32 v123, v123
    v_rcp_f32 v124, v124
    v_mfma_f32_32x32x16_bf16 v[164:179], v[56:59], v[240:243], v[164:179]
    v_rcp_f32 v125, v125
    v_rcp_f32 v126, v126
    v_rcp_f32 v127, v127
    s_waitcnt lgkmcnt(0)
    v_mfma_f32_32x32x16_bf16 v[180:195], v[20:23], v[228:231], v[148:163]
    v_rcp_f32 v128, v128
    v_rcp_f32 v129, v129
    v_rcp_f32 v130, v130
    v_mfma_f32_32x32x16_bf16 v[180:195], v[24:27], v[232:235], v[180:195]
    v_rcp_f32 v131, v131
    v_rcp_f32 v132, v132
    v_mfma_f32_32x32x16_bf16 v[180:195], v[28:31], v[236:239], v[180:195]
    v_rcp_f32 v133, v133
    v_rcp_f32 v134, v134
    v_rcp_f32 v135, v135
    v_mfma_f32_32x32x16_bf16 v[180:195], v[32:35], v[240:243], v[180:195]
    v_rcp_f32 v136, v136
    v_rcp_f32 v137, v137
    v_mfma_f32_32x32x16_bf16 v[196:211], v[36:39], v[228:231], v[164:179]
    v_rcp_f32 v138, v138
    v_rcp_f32 v139, v139
    v_rcp_f32 v140, v140
    v_mfma_f32_32x32x16_bf16 v[196:211], v[40:43], v[232:235], v[196:211]
    v_rcp_f32 v141, v141
    v_rcp_f32 v142, v142
    v_mfma_f32_32x32x16_bf16 v[196:211], v[44:47], v[236:239], v[196:211]
    v_rcp_f32 v143, v143
    v_rcp_f32 v144, v144
    v_rcp_f32 v145, v145
    v_mfma_f32_32x32x16_bf16 v[196:211], v[48:51], v[240:243], v[196:211]
    v_rcp_f32 v146, v146
    v_rcp_f32 v147, v147
    s_waitcnt vmcnt(0)
    v_pk_fma_f32 v[84:85], v[84:85], v[116:117], v[180:181]
    v_max_f32 v84, v148, v84
    v_max_f32 v85, v149, v85
    v_cvt_pk_bf16_f32 v212, v84, v85
    v_pk_fma_f32 v[86:87], v[86:87], v[118:119], v[182:183]
    v_max_f32 v86, v150, v86
    v_max_f32 v87, v151, v87
    v_cvt_pk_bf16_f32 v213, v86, v87
    v_pk_fma_f32 v[88:89], v[88:89], v[120:121], v[184:185]
    v_max_f32 v88, v152, v88
    v_max_f32 v89, v153, v89
    v_cvt_pk_bf16_f32 v214, v88, v89
    v_pk_fma_f32 v[90:91], v[90:91], v[122:123], v[186:187]
    v_max_f32 v90, v154, v90
    v_max_f32 v91, v155, v91
    v_cvt_pk_bf16_f32 v215, v90, v91
    ds_write_b128 v3, v[212:215]
    v_pk_fma_f32 v[92:93], v[92:93], v[124:125], v[188:189]
    v_max_f32 v92, v156, v92
    v_max_f32 v93, v157, v93
    v_cvt_pk_bf16_f32 v216, v92, v93
    v_pk_fma_f32 v[94:95], v[94:95], v[126:127], v[190:191]
    v_max_f32 v94, v158, v94
    v_max_f32 v95, v159, v95
    v_cvt_pk_bf16_f32 v217, v94, v95
    v_pk_fma_f32 v[96:97], v[96:97], v[128:129], v[192:193]
    v_max_f32 v96, v160, v96
    v_max_f32 v97, v161, v97
    v_cvt_pk_bf16_f32 v218, v96, v97
    v_pk_fma_f32 v[98:99], v[98:99], v[130:131], v[194:195]
    v_max_f32 v98, v162, v98
    v_max_f32 v99, v163, v99
    v_cvt_pk_bf16_f32 v219, v98, v99
    ds_write_b128 v4, v[216:219]
    v_pk_fma_f32 v[100:101], v[100:101], v[132:133], v[196:197]
    v_max_f32 v100, v164, v100
    v_max_f32 v101, v165, v101
    v_cvt_pk_bf16_f32 v220, v100, v101
    v_pk_fma_f32 v[102:103], v[102:103], v[134:135], v[198:199]
    v_max_f32 v102, v166, v102
    v_max_f32 v103, v167, v103
    v_cvt_pk_bf16_f32 v221, v102, v103
    v_pk_fma_f32 v[104:105], v[104:105], v[136:137], v[200:201]
    v_max_f32 v104, v168, v104
    v_max_f32 v105, v169, v105
    v_cvt_pk_bf16_f32 v222, v104, v105
    v_pk_fma_f32 v[106:107], v[106:107], v[138:139], v[202:203]
    v_max_f32 v106, v170, v106
    v_max_f32 v107, v171, v107
    v_cvt_pk_bf16_f32 v223, v106, v107
    ds_write_b128 v5, v[220:223]
    v_pk_fma_f32 v[108:109], v[108:109], v[140:141], v[204:205]
    v_max_f32 v108, v172, v108
    v_max_f32 v109, v173, v109
    v_cvt_pk_bf16_f32 v224, v108, v109
    v_pk_fma_f32 v[110:111], v[110:111], v[142:143], v[206:207]
    v_max_f32 v110, v174, v110
    v_max_f32 v111, v175, v111
    v_cvt_pk_bf16_f32 v225, v110, v111
    v_pk_fma_f32 v[112:113], v[112:113], v[144:145], v[208:209]
    v_max_f32 v112, v176, v112
    v_max_f32 v113, v177, v113
    v_cvt_pk_bf16_f32 v226, v112, v113
    v_pk_fma_f32 v[114:115], v[114:115], v[146:147], v[210:211]
    v_max_f32 v114, v178, v114
    v_max_f32 v115, v179, v115
    v_cvt_pk_bf16_f32 v227, v114, v115
    ds_write_b128 v6, v[224:227]
    ds_read_b128 v[228:231], v18 offset:0
    ds_read_b128 v[232:235], v18 offset:1024
    ds_read_b128 v[236:239], v18 offset:2048
    ds_read_b128 v[240:243], v18 offset:3072
    s_mov_b64 exec, s[52:53]
    s_waitcnt lgkmcnt(3)
    buffer_store_dwordx4 v[228:231], v12, s[16:19], 0 offen offset:0 nt
    s_waitcnt lgkmcnt(2)
    buffer_store_dwordx4 v[232:235], v13, s[16:19], 0 offen offset:1024 nt
    s_waitcnt lgkmcnt(1)
    buffer_store_dwordx4 v[236:239], v253, s[16:19], 0 offen offset:2048 nt
    s_waitcnt lgkmcnt(0)
    buffer_store_dwordx4 v[240:243], v254, s[16:19], 0 offen offset:3072 nt
K2_X:
    s_endpgm
K2_NOB0_O:
    s_mov_b32 s34, 1
    v_cmp_lt_u32_sdwa vcc, v231, v240 src0_sel:DWORD src1_sel:WORD_1
    s_nop 1
    v_cndmask_b32 v233, v232, v234, vcc
    buffer_load_dwordx4 v[188:191], v233, s[20:23], 0 offen offset:128
    v_cmp_lt_u32_sdwa vcc, v231, v241 src0_sel:DWORD src1_sel:WORD_1
    s_nop 1
    v_cndmask_b32 v233, v232, v235, vcc
    buffer_load_dwordx4 v[192:195], v233, s[20:23], s43 offen offset:128
    v_cmp_lt_u32_sdwa vcc, v231, v242 src0_sel:DWORD src1_sel:WORD_1
    s_nop 1
    v_cndmask_b32 v233, v232, v236, vcc
    buffer_load_dwordx4 v[196:199], v233, s[20:23], s44 offen offset:128
    v_cmp_lt_u32_sdwa vcc, v231, v243 src0_sel:DWORD src1_sel:WORD_1
    s_nop 1
    v_cndmask_b32 v233, v232, v237, vcc
    buffer_load_dwordx4 v[200:203], v233, s[20:23], s45 offen offset:128
    s_branch K2_NOB0
K2_NOB1_O:
    v_mov_b32 v204, 0x40000
    v_mov_b32 v205, v204
    v_mov_b64 v[206:207], v[204:205]
    v_mov_b64 v[208:209], v[204:205]
    v_mov_b64 v[210:211], v[204:205]
    v_mov_b64 v[212:213], v[204:205]
    v_mov_b64 v[214:215], v[204:205]
    v_lshlrev_b32_sdwa v216, 2, v191 dst_sel:DWORD dst_unused:UNUSED_PAD src0_sel:DWORD src1_sel:BYTE_0
    v_lshlrev_b32_sdwa v217, 2, v191 dst_sel:DWORD dst_unused:UNUSED_PAD src0_sel:DWORD src1_sel:BYTE_1
    v_lshlrev_b32_sdwa v218, 2, v191 dst_sel:DWORD dst_unused:UNUSED_PAD src0_sel:DWORD src1_sel:BYTE_2
    v_cmpx_ne_u32 vcc, 0, v216
    ds_add_rtn_u32 v204, v216, v10 offset:0
    v_cmpx_ne_u32 vcc, 0, v217
    ds_add_rtn_u32 v205, v217, v10 offset:0
    v_cmpx_ne_u32 vcc, 0, v218
    ds_add_rtn_u32 v206, v218, v10 offset:0
    s_mov_b64 exec, -1
    v_lshlrev_b32_sdwa v219, 2, v195 dst_sel:DWORD dst_unused:UNUSED_PAD src0_sel:DWORD src1_sel:BYTE_0
    v_lshlrev_b32_sdwa v220, 2, v195 dst_sel:DWORD dst_unused:UNUSED_PAD src0_sel:DWORD src1_sel:BYTE_1
    v_lshlrev_b32_sdwa v221, 2, v195 dst_sel:DWORD dst_unused:UNUSED_PAD src0_sel:DWORD src1_sel:BYTE_2
    v_cmpx_ne_u32 vcc, 0, v219
    ds_add_rtn_u32 v207, v219, v10 offset:0
    v_cmpx_ne_u32 vcc, 0, v220
    ds_add_rtn_u32 v208, v220, v10 offset:0
    v_cmpx_ne_u32 vcc, 0, v221
    ds_add_rtn_u32 v209, v221, v10 offset:0
    s_mov_b64 exec, -1
    v_lshlrev_b32_sdwa v222, 2, v199 dst_sel:DWORD dst_unused:UNUSED_PAD src0_sel:DWORD src1_sel:BYTE_0
    v_lshlrev_b32_sdwa v223, 2, v199 dst_sel:DWORD dst_unused:UNUSED_PAD src0_sel:DWORD src1_sel:BYTE_1
    v_lshlrev_b32_sdwa v224, 2, v199 dst_sel:DWORD dst_unused:UNUSED_PAD src0_sel:DWORD src1_sel:BYTE_2
    v_cmpx_ne_u32 vcc, 0, v222
    ds_add_rtn_u32 v210, v222, v10 offset:0
    v_cmpx_ne_u32 vcc, 0, v223
    ds_add_rtn_u32 v211, v223, v10 offset:0
    v_cmpx_ne_u32 vcc, 0, v224
    ds_add_rtn_u32 v212, v224, v10 offset:0
    s_mov_b64 exec, -1
    v_lshlrev_b32_sdwa v225, 2, v203 dst_sel:DWORD dst_unused:UNUSED_PAD src0_sel:DWORD src1_sel:BYTE_0
    v_lshlrev_b32_sdwa v226, 2, v203 dst_sel:DWORD dst_unused:UNUSED_PAD src0_sel:DWORD src1_sel:BYTE_1
    v_lshlrev_b32_sdwa v227, 2, v203 dst_sel:DWORD dst_unused:UNUSED_PAD src0_sel:DWORD src1_sel:BYTE_2
    v_cmpx_ne_u32 vcc, 0, v225
    ds_add_rtn_u32 v213, v225, v10 offset:0
    v_cmpx_ne_u32 vcc, 0, v226
    ds_add_rtn_u32 v214, v226, v10 offset:0
    v_cmpx_ne_u32 vcc, 0, v227
    ds_add_rtn_u32 v215, v227, v10 offset:0
    s_mov_b64 exec, -1
    s_branch K2_NOB1
K2_NOB2_O:
    ds_read_b32 v216, v216 offset:6144
    ds_read_b32 v217, v217 offset:6144
    ds_read_b32 v218, v218 offset:6144
    ds_read_b32 v219, v219 offset:6144
    ds_read_b32 v220, v220 offset:6144
    ds_read_b32 v221, v221 offset:6144
    ds_read_b32 v222, v222 offset:6144
    ds_read_b32 v223, v223 offset:6144
    ds_read_b32 v224, v224 offset:6144
    ds_read_b32 v225, v225 offset:6144
    ds_read_b32 v226, v226 offset:6144
    ds_read_b32 v227, v227 offset:6144
    s_waitcnt lgkmcnt(0)
    v_mad_u16 v204, v204, v216, v216 op_sel:[0,1,0,0]
    ds_write_b32 v204, v188
    v_mad_u16 v205, v205, v217, v217 op_sel:[0,1,0,0]
    ds_write_b32 v205, v189
    v_mad_u16 v206, v206, v218, v218 op_sel:[0,1,0,0]
    ds_write_b32 v206, v190
    v_mad_u16 v207, v207, v219, v219 op_sel:[0,1,0,0]
    ds_write_b32 v207, v192
    v_mad_u16 v208, v208, v220, v220 op_sel:[0,1,0,0]
    ds_write_b32 v208, v193
    v_mad_u16 v209, v209, v221, v221 op_sel:[0,1,0,0]
    ds_write_b32 v209, v194
    v_mad_u16 v210, v210, v222, v222 op_sel:[0,1,0,0]
    ds_write_b32 v210, v196
    v_mad_u16 v211, v211, v223, v223 op_sel:[0,1,0,0]
    ds_write_b32 v211, v197
    v_mad_u16 v212, v212, v224, v224 op_sel:[0,1,0,0]
    ds_write_b32 v212, v198
    v_mad_u16 v213, v213, v225, v225 op_sel:[0,1,0,0]
    ds_write_b32 v213, v200
    v_mad_u16 v214, v214, v226, v226 op_sel:[0,1,0,0]
    ds_write_b32 v214, v201
    v_mad_u16 v215, v215, v227, v227 op_sel:[0,1,0,0]
    ds_write_b32 v215, v202
    s_branch K2_NOB2
K2_SLOW:
    s_waitcnt vmcnt(0) lgkmcnt(0)
    s_mov_b32 s38, 1
    s_mov_b32 s39, 0
    s_mov_b32 s59, -1
    s_lshl_b32 s3, s29, 12
    v_and_b32 v254, 0xfff, v7
    v_add_u32 v254, s3, v254
    v_and_b32 v255, 0xfff, v8
    v_add_u32 v255, s3, v255
    ds_read_b128 v[196:199], v238 offset:4096
    ds_read_b128 v[200:203], v238 offset:5120
    ds_read_b128 v[204:207], v238 offset:6144
    ds_read_b128 v[208:211], v238 offset:7168
    ds_read_b128 v[212:215], v238 offset:8192
    ds_read_b128 v[216:219], v238 offset:9216
    ds_read_b128 v[220:223], v238 offset:10240
    ds_read_b128 v[224:227], v238 offset:11264
    v_lshlrev_b32 v11, 4, v9
    ds_read_b128 v[20:23], v11 offset:40960
    ds_read_b128 v[24:27], v11 offset:41984
    ds_read_b128 v[28:31], v11 offset:43008
    ds_read_b128 v[32:35], v11 offset:44032
    ds_read_b128 v[36:39], v11 offset:45056
    ds_read_b128 v[40:43], v11 offset:46080
    ds_read_b128 v[44:47], v11 offset:47104
    ds_read_b128 v[48:51], v11 offset:48128
    ds_read_b128 v[52:55], v11 offset:49152
    ds_read_b128 v[56:59], v11 offset:50176
    ds_read_b128 v[60:63], v11 offset:51200
    ds_read_b128 v[64:67], v11 offset:52224
    ds_read_b128 v[68:71], v11 offset:53248
    ds_read_b128 v[72:75], v11 offset:54272
    ds_read_b128 v[76:79], v11 offset:55296
    ds_read_b128 v[80:83], v11 offset:56320
    s_lshl_b32 s42, s29, 5
    v_bfe_u32 v228, v254, 2, 5
    v_add_u32 v228, s42, v228
    v_mov_b32 v229, 0xffff
    v_add_u32 v230, 0, v228
    v_cmp_gt_u32 vcc, s33, v230
    v_add_u32 v230, s32, v230
    s_nop 1
    v_cndmask_b32 v248, v229, v230, vcc
    v_add_u32 v230, 1, v228
    v_cmp_gt_u32 vcc, s33, v230
    v_add_u32 v230, s32, v230
    s_nop 1
    v_cndmask_b32 v249, v229, v230, vcc
    v_add_u32 v230, 2, v228
    v_cmp_gt_u32 vcc, s33, v230
    v_add_u32 v230, s32, v230
    s_nop 1
    v_cndmask_b32 v250, v229, v230, vcc
    v_add_u32 v230, 3, v228
    v_cmp_gt_u32 vcc, s33, v230
    v_add_u32 v230, s32, v230
    s_nop 1
    v_cndmask_b32 v251, v229, v230, vcc
    v_bfe_u32 v228, v255, 2, 5
    v_add_u32 v228, s42, v228
    v_cmp_gt_u32 vcc, s33, v228
    v_add_u32 v228, s32, v228
    s_nop 1
    v_cndmask_b32 v252, v229, v228, vcc
    s_add_u32 m0, s35, 0
    v_mad_u32_u16 v248, v248, s36, v1
    buffer_load_dwordx4 v248, s[60:63], 0 offen offset:0 lds
    v_mad_u32_u16 v249, v249, s36, v2
    buffer_load_dwordx4 v249, s[60:63], 0 offen offset:1024 lds
    v_mad_u32_u16 v250, v250, s36, v14
    buffer_load_dwordx4 v250, s[60:63], 0 offen offset:2048 lds
    v_mad_u32_u16 v251, v251, s36, v15
    buffer_load_dwordx4 v251, s[60:63], 0 offen offset:3072 lds
    s_waitcnt vmcnt(0)
    ds_read_b128 v[228:231], v3 offset:0
    ds_read_b128 v[232:235], v4 offset:0
    ds_read_b128 v[236:239], v5 offset:0
    ds_read_b128 v[240:243], v6 offset:0
    s_waitcnt lgkmcnt(0)
    v_mfma_f32_32x32x16_bf16 v[148:163], v[196:199], v[228:231], 0
    v_mfma_f32_32x32x16_bf16 v[148:163], v[200:203], v[232:235], v[148:163]
    v_mfma_f32_32x32x16_bf16 v[148:163], v[204:207], v[236:239], v[148:163]
    v_mfma_f32_32x32x16_bf16 v[148:163], v[208:211], v[240:243], v[148:163]
    v_mfma_f32_32x32x16_bf16 v[164:179], v[212:215], v[228:231], 0
    v_mfma_f32_32x32x16_bf16 v[164:179], v[216:219], v[232:235], v[164:179]
    v_mfma_f32_32x32x16_bf16 v[164:179], v[220:223], v[236:239], v[164:179]
    v_mfma_f32_32x32x16_bf16 v[164:179], v[224:227], v[240:243], v[164:179]
    s_mov_b32 s40, 0xbfb8aa3b
    s_mov_b32 s41, 0xbfb8aa3b
    v_mov_b32 v116, 0x358637bd
    v_mov_b32 v117, 0x358637bd
    v_mov_b32 v118, 0x358637bd
    v_mov_b32 v119, 0x358637bd
    v_mov_b32 v120, 0x358637bd
    v_mov_b32 v121, 0x358637bd
    v_mov_b32 v122, 0x358637bd
    v_mov_b32 v123, 0x358637bd
    v_mov_b32 v124, 0x358637bd
    v_mov_b32 v125, 0x358637bd
    v_mov_b32 v126, 0x358637bd
    v_mov_b32 v127, 0x358637bd
    v_mov_b32 v128, 0x358637bd
    v_mov_b32 v129, 0x358637bd
    v_mov_b32 v130, 0x358637bd
    v_mov_b32 v131, 0x358637bd
    v_mov_b32 v132, 0x358637bd
    v_mov_b32 v133, 0x358637bd
    v_mov_b32 v134, 0x358637bd
    v_mov_b32 v135, 0x358637bd
    v_mov_b32 v136, 0x358637bd
    v_mov_b32 v137, 0x358637bd
    v_mov_b32 v138, 0x358637bd
    v_mov_b32 v139, 0x358637bd
    v_mov_b32 v140, 0x358637bd
    v_mov_b32 v141, 0x358637bd
    v_mov_b32 v142, 0x358637bd
    v_mov_b32 v143, 0x358637bd
    v_mov_b32 v144, 0x358637bd
    v_mov_b32 v145, 0x358637bd
    v_mov_b32 v146, 0x358637bd
    v_mov_b32 v147, 0x358637bd
    v_mov_b32 v84, 0
    v_mov_b32 v85, 0
    v_mov_b32 v86, 0
    v_mov_b32 v87, 0
    v_mov_b32 v88, 0
    v_mov_b32 v89, 0
    v_mov_b32 v90, 0
    v_mov_b32 v91, 0
    v_mov_b32 v92, 0
    v_mov_b32 v93, 0
    v_mov_b32 v94, 0
    v_mov_b32 v95, 0
    v_mov_b32 v96, 0
    v_mov_b32 v97, 0
    v_mov_b32 v98, 0
    v_mov_b32 v99, 0
    v_mov_b32 v100, 0
    v_mov_b32 v101, 0
    v_mov_b32 v102, 0
    v_mov_b32 v103, 0
    v_mov_b32 v104, 0
    v_mov_b32 v105, 0
    v_mov_b32 v106, 0
    v_mov_b32 v107, 0
    v_mov_b32 v108, 0
    v_mov_b32 v109, 0
    v_mov_b32 v110, 0
    v_mov_b32 v111, 0
    v_mov_b32 v112, 0
    v_mov_b32 v113, 0
    v_mov_b32 v114, 0
    v_mov_b32 v115, 0
    s_mov_b32 s56, 0
K2_SLOW_PASS:
    v_mov_b32 v253, 0xfff
K2_SLOW_ROUND:
    s_barrier
    v_lshrrev_b32 v13, 3, v0
    v_lshlrev_b32 v13, 10, v13
    s_lshl_b32 s42, s28, 2
    s_add_u32 s43, s42, 65536
    s_add_u32 s44, s42, 131072
    s_add_u32 s45, s42, 196608
    buffer_load_dword v240, v13, s[24:27], s42 offen
    buffer_load_dword v241, v13, s[24:27], s43 offen
    buffer_load_dword v242, v13, s[24:27], s44 offen
    buffer_load_dword v243, v13, s[24:27], s45 offen
    v_lshlrev_b32 v11, 4, v0
    v_mov_b32 v228, 0xffff
    v_mov_b32 v229, 0xffff
    v_mov_b32 v230, 0xffff
    v_mov_b32 v231, 0xffff
    ds_write_b128 v11, v[228:231] offset:8192
    ds_write_b128 v11, v[228:231] offset:16384
    ds_write_b128 v11, v[228:231] offset:24576
    ds_write_b128 v11, v[228:231] offset:32768
    v_mov_b32 v232, 0
    v_lshlrev_b32 v233, 2, v0
    ds_write_b32 v233, v232
    v_and_b32 v234, 7, v0
    v_add_u32 v234, s56, v234
    s_lshl_b32 s42, s56, 4
    v_add_u32 v235, s42, v12
    v_bfrev_b32 v236, 1
    s_mov_b32 s43, 1269760
    s_mov_b32 s44, 2539520
    s_mov_b32 s45, 3809280
    s_waitcnt vmcnt(0)
    v_cmp_lt_u32_sdwa vcc, v234, v240 src0_sel:DWORD src1_sel:WORD_1
    v_mad_u32_u16 v237, v240, 16, v235
    s_nop 0
    v_cndmask_b32 v237, v236, v237, vcc
    buffer_load_dwordx4 v[180:183], v237, s[20:23], 0 offen
    v_cmp_lt_u32_sdwa vcc, v234, v241 src0_sel:DWORD src1_sel:WORD_1
    v_mad_u32_u16 v237, v241, 16, v235
    s_nop 0
    v_cndmask_b32 v237, v236, v237, vcc
    buffer_load_dwordx4 v[184:187], v237, s[20:23], s43 offen
    v_cmp_lt_u32_sdwa vcc, v234, v242 src0_sel:DWORD src1_sel:WORD_1
    v_mad_u32_u16 v237, v242, 16, v235
    s_nop 0
    v_cndmask_b32 v237, v236, v237, vcc
    buffer_load_dwordx4 v[188:191], v237, s[20:23], s44 offen
    v_cmp_lt_u32_sdwa vcc, v234, v243 src0_sel:DWORD src1_sel:WORD_1
    v_mad_u32_u16 v237, v243, 16, v235
    s_nop 0
    v_cndmask_b32 v237, v236, v237, vcc
    buffer_load_dwordx4 v[192:195], v237, s[20:23], s45 offen
    v_max3_u32 v238, v240, v241, v242
    v_max_u32 v238, v238, v243
    v_lshrrev_b32 v238, 16, v238
    s_add_u32 s42, s56, 8
    s_waitcnt lgkmcnt(0)
    s_barrier
    v_cmpx_lt_u32 vcc, s42, v238
    ds_write_b32 v232, v10 offset:1284
    s_mov_b64 exec, -1
    s_waitcnt vmcnt(0)
    v_lshlrev_b32_sdwa v208, 2, v183 dst_sel:DWORD dst_unused:UNUSED_PAD src0_sel:DWORD src1_sel:BYTE_0
    v_bfe_u32 v233, v253, 0, 1
    v_mul_u32_u24 v208, v208, v233
    v_cmpx_ne_u32 vcc, 0, v208
    ds_add_rtn_u32 v196, v208, v10 offset:0
    s_mov_b64 exec, -1
    v_lshlrev_b32_sdwa v209, 2, v183 dst_sel:DWORD dst_unused:UNUSED_PAD src0_sel:DWORD src1_sel:BYTE_1
    v_bfe_u32 v233, v253, 1, 1
    v_mul_u32_u24 v209, v209, v233
    v_cmpx_ne_u32 vcc, 0, v209
    ds_add_rtn_u32 v197, v209, v10 offset:0
    s_mov_b64 exec, -1
    v_lshlrev_b32_sdwa v210, 2, v183 dst_sel:DWORD dst_unused:UNUSED_PAD src0_sel:DWORD src1_sel:BYTE_2
    v_bfe_u32 v233, v253, 2, 1
    v_mul_u32_u24 v210, v210, v233
    v_cmpx_ne_u32 vcc, 0, v210
    ds_add_rtn_u32 v198, v210, v10 offset:0
    s_mov_b64 exec, -1
    v_lshlrev_b32_sdwa v211, 2, v187 dst_sel:DWORD dst_unused:UNUSED_PAD src0_sel:DWORD src1_sel:BYTE_0
    v_bfe_u32 v233, v253, 3, 1
    v_mul_u32_u24 v211, v211, v233
    v_cmpx_ne_u32 vcc, 0, v211
    ds_add_rtn_u32 v199, v211, v10 offset:0
    s_mov_b64 exec, -1
    v_lshlrev_b32_sdwa v212, 2, v187 dst_sel:DWORD dst_unused:UNUSED_PAD src0_sel:DWORD src1_sel:BYTE_1
    v_bfe_u32 v233, v253, 4, 1
    v_mul_u32_u24 v212, v212, v233
    v_cmpx_ne_u32 vcc, 0, v212
    ds_add_rtn_u32 v200, v212, v10 offset:0
    s_mov_b64 exec, -1
    v_lshlrev_b32_sdwa v213, 2, v187 dst_sel:DWORD dst_unused:UNUSED_PAD src0_sel:DWORD src1_sel:BYTE_2
    v_bfe_u32 v233, v253, 5, 1
    v_mul_u32_u24 v213, v213, v233
    v_cmpx_ne_u32 vcc, 0, v213
    ds_add_rtn_u32 v201, v213, v10 offset:0
    s_mov_b64 exec, -1
    v_lshlrev_b32_sdwa v214, 2, v191 dst_sel:DWORD dst_unused:UNUSED_PAD src0_sel:DWORD src1_sel:BYTE_0
    v_bfe_u32 v233, v253, 6, 1
    v_mul_u32_u24 v214, v214, v233
    v_cmpx_ne_u32 vcc, 0, v214
    ds_add_rtn_u32 v202, v214, v10 offset:0
    s_mov_b64 exec, -1
    v_lshlrev_b32_sdwa v215, 2, v191 dst_sel:DWORD dst_unused:UNUSED_PAD src0_sel:DWORD src1_sel:BYTE_1
    v_bfe_u32 v233, v253, 7, 1
    v_mul_u32_u24 v215, v215, v233
    v_cmpx_ne_u32 vcc, 0, v215
    ds_add_rtn_u32 v203, v215, v10 offset:0
    s_mov_b64 exec, -1
    v_lshlrev_b32_sdwa v216, 2, v191 dst_sel:DWORD dst_unused:UNUSED_PAD src0_sel:DWORD src1_sel:BYTE_2
    v_bfe_u32 v233, v253, 8, 1
    v_mul_u32_u24 v216, v216, v233
    v_cmpx_ne_u32 vcc, 0, v216
    ds_add_rtn_u32 v204, v216, v10 offset:0
    s_mov_b64 exec, -1
    v_lshlrev_b32_sdwa v217, 2, v195 dst_sel:DWORD dst_unused:UNUSED_PAD src0_sel:DWORD src1_sel:BYTE_0
    v_bfe_u32 v233, v253, 9, 1
    v_mul_u32_u24 v217, v217, v233
    v_cmpx_ne_u32 vcc, 0, v217
    ds_add_rtn_u32 v205, v217, v10 offset:0
    s_mov_b64 exec, -1
    v_lshlrev_b32_sdwa v218, 2, v195 dst_sel:DWORD dst_unused:UNUSED_PAD src0_sel:DWORD src1_sel:BYTE_1
    v_bfe_u32 v233, v253, 10, 1
    v_mul_u32_u24 v218, v218, v233
    v_cmpx_ne_u32 vcc, 0, v218
    ds_add_rtn_u32 v206, v218, v10 offset:0
    s_mov_b64 exec, -1
    v_lshlrev_b32_sdwa v219, 2, v195 dst_sel:DWORD dst_unused:UNUSED_PAD src0_sel:DWORD src1_sel:BYTE_2
    v_bfe_u32 v233, v253, 11, 1
    v_mul_u32_u24 v219, v219, v233
    v_cmpx_ne_u32 vcc, 0, v219
    ds_add_rtn_u32 v207, v219, v10 offset:0
    s_mov_b64 exec, -1
    v_mov_b32 v253, 0
    s_waitcnt lgkmcnt(0)
    v_or_b32 v233, 1, v253
    v_cmpx_ne_u32 vcc, 0, v208
    v_cmp_le_u32 vcc, 28, v196
    v_subrev_u32 v208, 4, v208
    s_nop 1
    v_cndmask_b32 v253, v253, v233, vcc
    v_cmpx_gt_u32 vcc, 28, v196
    v_lshrrev_b32 v234, 7, v208
    v_and_b32 v208, 127, v208
    v_lshl_add_u32 v208, v234, 12, v208
    v_lshl_add_u32 v208, v196, 7, v208
    ds_write_b32 v208, v180 offset:8320
    v_lshlrev_b32 v220, 2, v234
    v_add_u32 v196, 1, v196
    ds_max_u32 v220, v196 offset:1536
    s_mov_b64 exec, -1
    v_or_b32 v233, 2, v253
    v_cmpx_ne_u32 vcc, 0, v209
    v_cmp_le_u32 vcc, 28, v197
    v_subrev_u32 v209, 4, v209
    s_nop 1
    v_cndmask_b32 v253, v253, v233, vcc
    v_cmpx_gt_u32 vcc, 28, v197
    v_lshrrev_b32 v234, 7, v209
    v_and_b32 v209, 127, v209
    v_lshl_add_u32 v209, v234, 12, v209
    v_lshl_add_u32 v209, v197, 7, v209
    ds_write_b32 v209, v181 offset:8320
    v_lshlrev_b32 v221, 2, v234
    v_add_u32 v197, 1, v197
    ds_max_u32 v221, v197 offset:1536
    s_mov_b64 exec, -1
    v_or_b32 v233, 4, v253
    v_cmpx_ne_u32 vcc, 0, v210
    v_cmp_le_u32 vcc, 28, v198
    v_subrev_u32 v210, 4, v210
    s_nop 1
    v_cndmask_b32 v253, v253, v233, vcc
    v_cmpx_gt_u32 vcc, 28, v198
    v_lshrrev_b32 v234, 7, v210
    v_and_b32 v210, 127, v210
    v_lshl_add_u32 v210, v234, 12, v210
    v_lshl_add_u32 v210, v198, 7, v210
    ds_write_b32 v210, v182 offset:8320
    v_lshlrev_b32 v222, 2, v234
    v_add_u32 v198, 1, v198
    ds_max_u32 v222, v198 offset:1536
    s_mov_b64 exec, -1
    v_or_b32 v233, 8, v253
    v_cmpx_ne_u32 vcc, 0, v211
    v_cmp_le_u32 vcc, 28, v199
    v_subrev_u32 v211, 4, v211
    s_nop 1
    v_cndmask_b32 v253, v253, v233, vcc
    v_cmpx_gt_u32 vcc, 28, v199
    v_lshrrev_b32 v234, 7, v211
    v_and_b32 v211, 127, v211
    v_lshl_add_u32 v211, v234, 12, v211
    v_lshl_add_u32 v211, v199, 7, v211
    ds_write_b32 v211, v184 offset:8320
    v_lshlrev_b32 v223, 2, v234
    v_add_u32 v199, 1, v199
    ds_max_u32 v223, v199 offset:1536
    s_mov_b64 exec, -1
    v_or_b32 v233, 16, v253
    v_cmpx_ne_u32 vcc, 0, v212
    v_cmp_le_u32 vcc, 28, v200
    v_subrev_u32 v212, 4, v212
    s_nop 1
    v_cndmask_b32 v253, v253, v233, vcc
    v_cmpx_gt_u32 vcc, 28, v200
    v_lshrrev_b32 v234, 7, v212
    v_and_b32 v212, 127, v212
    v_lshl_add_u32 v212, v234, 12, v212
    v_lshl_add_u32 v212, v200, 7, v212
    ds_write_b32 v212, v185 offset:8320
    v_lshlrev_b32 v220, 2, v234
    v_add_u32 v200, 1, v200
    ds_max_u32 v220, v200 offset:1536
    s_mov_b64 exec, -1
    v_or_b32 v233, 32, v253
    v_cmpx_ne_u32 vcc, 0, v213
    v_cmp_le_u32 vcc, 28, v201
    v_subrev_u32 v213, 4, v213
    s_nop 1
    v_cndmask_b32 v253, v253, v233, vcc
    v_cmpx_gt_u32 vcc, 28, v201
    v_lshrrev_b32 v234, 7, v213
    v_and_b32 v213, 127, v213
    v_lshl_add_u32 v213, v234, 12, v213
    v_lshl_add_u32 v213, v201, 7, v213
    ds_write_b32 v213, v186 offset:8320
    v_lshlrev_b32 v221, 2, v234
    v_add_u32 v201, 1, v201
    ds_max_u32 v221, v201 offset:1536
    s_mov_b64 exec, -1
    v_or_b32 v233, 64, v253
    v_cmpx_ne_u32 vcc, 0, v214
    v_cmp_le_u32 vcc, 28, v202
    v_subrev_u32 v214, 4, v214
    s_nop 1
    v_cndmask_b32 v253, v253, v233, vcc
    v_cmpx_gt_u32 vcc, 28, v202
    v_lshrrev_b32 v234, 7, v214
    v_and_b32 v214, 127, v214
    v_lshl_add_u32 v214, v234, 12, v214
    v_lshl_add_u32 v214, v202, 7, v214
    ds_write_b32 v214, v188 offset:8320
    v_lshlrev_b32 v222, 2, v234
    v_add_u32 v202, 1, v202
    ds_max_u32 v222, v202 offset:1536
    s_mov_b64 exec, -1
    v_or_b32 v233, 128, v253
    v_cmpx_ne_u32 vcc, 0, v215
    v_cmp_le_u32 vcc, 28, v203
    v_subrev_u32 v215, 4, v215
    s_nop 1
    v_cndmask_b32 v253, v253, v233, vcc
    v_cmpx_gt_u32 vcc, 28, v203
    v_lshrrev_b32 v234, 7, v215
    v_and_b32 v215, 127, v215
    v_lshl_add_u32 v215, v234, 12, v215
    v_lshl_add_u32 v215, v203, 7, v215
    ds_write_b32 v215, v189 offset:8320
    v_lshlrev_b32 v223, 2, v234
    v_add_u32 v203, 1, v203
    ds_max_u32 v223, v203 offset:1536
    s_mov_b64 exec, -1
    v_or_b32 v233, 256, v253
    v_cmpx_ne_u32 vcc, 0, v216
    v_cmp_le_u32 vcc, 28, v204
    v_subrev_u32 v216, 4, v216
    s_nop 1
    v_cndmask_b32 v253, v253, v233, vcc
    v_cmpx_gt_u32 vcc, 28, v204
    v_lshrrev_b32 v234, 7, v216
    v_and_b32 v216, 127, v216
    v_lshl_add_u32 v216, v234, 12, v216
    v_lshl_add_u32 v216, v204, 7, v216
    ds_write_b32 v216, v190 offset:8320
    v_lshlrev_b32 v220, 2, v234
    v_add_u32 v204, 1, v204
    ds_max_u32 v220, v204 offset:1536
    s_mov_b64 exec, -1
    v_or_b32 v233, 512, v253
    v_cmpx_ne_u32 vcc, 0, v217
    v_cmp_le_u32 vcc, 28, v205
    v_subrev_u32 v217, 4, v217
    s_nop 1
    v_cndmask_b32 v253, v253, v233, vcc
    v_cmpx_gt_u32 vcc, 28, v205
    v_lshrrev_b32 v234, 7, v217
    v_and_b32 v217, 127, v217
    v_lshl_add_u32 v217, v234, 12, v217
    v_lshl_add_u32 v217, v205, 7, v217
    ds_write_b32 v217, v192 offset:8320
    v_lshlrev_b32 v221, 2, v234
    v_add_u32 v205, 1, v205
    ds_max_u32 v221, v205 offset:1536
    s_mov_b64 exec, -1
    v_or_b32 v233, 1024, v253
    v_cmpx_ne_u32 vcc, 0, v218
    v_cmp_le_u32 vcc, 28, v206
    v_subrev_u32 v218, 4, v218
    s_nop 1
    v_cndmask_b32 v253, v253, v233, vcc
    v_cmpx_gt_u32 vcc, 28, v206
    v_lshrrev_b32 v234, 7, v218
    v_and_b32 v218, 127, v218
    v_lshl_add_u32 v218, v234, 12, v218
    v_lshl_add_u32 v218, v206, 7, v218
    ds_write_b32 v218, v193 offset:8320
    v_lshlrev_b32 v222, 2, v234
    v_add_u32 v206, 1, v206
    ds_max_u32 v222, v206 offset:1536
    s_mov_b64 exec, -1
    v_or_b32 v233, 2048, v253
    v_cmpx_ne_u32 vcc, 0, v219
    v_cmp_le_u32 vcc, 28, v207
    v_subrev_u32 v219, 4, v219
    s_nop 1
    v_cndmask_b32 v253, v253, v233, vcc
    v_cmpx_gt_u32 vcc, 28, v207
    v_lshrrev_b32 v234, 7, v219
    v_and_b32 v219, 127, v219
    v_lshl_add_u32 v219, v234, 12, v219
    v_lshl_add_u32 v219, v207, 7, v219
    ds_write_b32 v219, v194 offset:8320
    v_lshlrev_b32 v223, 2, v234
    v_add_u32 v207, 1, v207
    ds_max_u32 v223, v207 offset:1536
    s_mov_b64 exec, -1
    v_cmpx_ne_u32 vcc, 0, v253
    ds_write_b32 v232, v10 offset:1280
    s_mov_b64 exec, -1
    s_waitcnt lgkmcnt(0)
    s_barrier
    s_lshl_b32 s42, s29, 2
    v_mov_b32 v233, s42
    ds_read_b64 v[228:229], v232 offset:1280
    ds_read_b32 v230, v233 offset:1536
    v_mov_b32 v7, v254
    v_mov_b32 v8, v255
    ds_read_b128 v[180:183], v7 offset:8320
    ds_read_b128 v[184:187], v7 offset:8448
    ds_read_b128 v[188:191], v7 offset:8576
    ds_read_b32 v252, v8 offset:8320
    ds_read_b128 v[248:251], v7 offset:8704
    s_waitcnt lgkmcnt(0)
    v_readfirstlane_b32 s57, v228
    v_readfirstlane_b32 s58, v229
    v_readfirstlane_b32 s31, v230
    s_add_u32 m0, s35, 4096
    v_mad_u32_u16 v180, v180, s36, v1
    buffer_load_dwordx4 v180, s[60:63], 0 offen offset:0 lds
    v_mad_u32_u16 v181, v181, s36, v2
    buffer_load_dwordx4 v181, s[60:63], 0 offen offset:1024 lds
    v_mad_u32_u16 v182, v182, s36, v14
    buffer_load_dwordx4 v182, s[60:63], 0 offen offset:2048 lds
    v_mad_u32_u16 v183, v183, s36, v15
    buffer_load_dwordx4 v183, s[60:63], 0 offen offset:3072 lds
    s_add_u32 m0, s35, 8192
    v_mad_u32_u16 v184, v184, s36, v1
    buffer_load_dwordx4 v184, s[60:63], 0 offen offset:0 lds
    v_mad_u32_u16 v185, v185, s36, v2
    buffer_load_dwordx4 v185, s[60:63], 0 offen offset:1024 lds
    v_mad_u32_u16 v186, v186, s36, v14
    buffer_load_dwordx4 v186, s[60:63], 0 offen offset:2048 lds
    v_mad_u32_u16 v187, v187, s36, v15
    buffer_load_dwordx4 v187, s[60:63], 0 offen offset:3072 lds
    v_pk_sub_u16 v244, v252, s37 clamp
    s_branch K2_PIPE
K2_SLOW_NEXT:
    s_nop 7
    s_nop 7
    s_nop 7
    s_waitcnt vmcnt(0) lgkmcnt(0)
    s_cmp_lg_u32 s57, 0
    s_cbranch_scc1 K2_SLOW_ROUND
    s_add_u32 s56, s56, 8
    s_cmp_lg_u32 s58, 0
    s_cbranch_scc1 K2_SLOW_PASS
    s_lshl_b32 s42, s29, 5
    v_bfe_u32 v228, v254, 2, 5
    v_add_u32 v228, s42, v228
    v_mov_b32 v229, 0xffff
    v_add_u32 v230, 0, v228
    v_cmp_gt_u32 vcc, s33, v230
    v_add_u32 v230, s32, v230
    s_nop 1
    v_cndmask_b32 v248, v229, v230, vcc
    v_add_u32 v230, 1, v228
    v_cmp_gt_u32 vcc, s33, v230
    v_add_u32 v230, s32, v230
    s_nop 1
    v_cndmask_b32 v249, v229, v230, vcc
    v_add_u32 v230, 2, v228
    v_cmp_gt_u32 vcc, s33, v230
    v_add_u32 v230, s32, v230
    s_nop 1
    v_cndmask_b32 v250, v229, v230, vcc
    v_add_u32 v230, 3, v228
    v_cmp_gt_u32 vcc, s33, v230
    v_add_u32 v230, s32, v230
    s_nop 1
    v_cndmask_b32 v251, v229, v230, vcc
    v_bfe_u32 v228, v255, 2, 5
    v_add_u32 v228, s42, v228
    v_cmp_gt_u32 vcc, s33, v228
    v_add_u32 v228, s32, v228
    s_nop 1
    v_cndmask_b32 v252, v229, v228, vcc
    s_add_u32 m0, s35, 0
    v_mad_u32_u16 v12, v248, s36, v1
    buffer_load_dwordx4 v12, s[60:63], 0 offen offset:0 lds
    v_mad_u32_u16 v13, v249, s36, v2
    buffer_load_dwordx4 v13, s[60:63], 0 offen offset:1024 lds
    v_mad_u32_u16 v253, v250, s36, v14
    buffer_load_dwordx4 v253, s[60:63], 0 offen offset:2048 lds
    v_mad_u32_u16 v254, v251, s36, v15
    buffer_load_dwordx4 v254, s[60:63], 0 offen offset:3072 lds
    s_waitcnt vmcnt(0)
    ds_read_b128 v[228:231], v3 offset:0
    ds_read_b128 v[232:235], v4 offset:0
    ds_read_b128 v[236:239], v5 offset:0
    ds_read_b128 v[240:243], v6 offset:0
    s_waitcnt lgkmcnt(0)
    s_mov_b64 s[52:53], -1
    s_branch K2_EPI
.section .rodata,"a"
.p2align 6
.amdhsa_kernel gcn_bin_kernel
  .amdhsa_next_free_vgpr 64
  .amdhsa_next_free_sgpr 96
  .amdhsa_accum_offset 64
  .amdhsa_group_segment_fixed_size 0
  .amdhsa_kernarg_size 96
  .amdhsa_user_sgpr_count 2
  .amdhsa_user_sgpr_kernarg_segment_ptr 1
  .amdhsa_system_sgpr_workgroup_id_x 1
  .amdhsa_float_denorm_mode_32 3
.end_amdhsa_kernel
.p2align 6
.amdhsa_kernel gather_scatter__edge_featured_mpnn_gatedgcn__graph_kernel
  .amdhsa_next_free_vgpr 256
  .amdhsa_next_free_sgpr 100
  .amdhsa_accum_offset 256
  .amdhsa_group_segment_fixed_size 0
  .amdhsa_kernarg_size 96
  .amdhsa_user_sgpr_count 2
  .amdhsa_user_sgpr_kernarg_segment_ptr 1
  .amdhsa_system_sgpr_workgroup_id_x 1
  .amdhsa_float_denorm_mode_32 3
.end_amdhsa_kernel
```
